```python
import torch

def _softmax(x, axis=-1):
    return torch.softmax(x, dim=axis)
def _gelu(x):
    return torch.nn.functional.gelu(x, approximate="tanh")
def _silu(x):
    return torch.nn.functional.silu(x)
def _sigmoid(x):
    return torch.sigmoid(x)
def _layernorm(x, axis=-1, eps=1e-5):
    m = x.mean(dim=axis, keepdim=True)
    v = x.var(dim=axis, keepdim=True, unbiased=False)
    return (x - m) / torch.sqrt(v + eps)
def _scatter_add(tgt, idx, src, axis=0):
    return tgt.clone().index_add_(axis, idx, src)
def _segment_sum(src, seg, n):
    out = torch.zeros((n,) + src.shape[1:], dtype=src.dtype)
    return out.index_add_(0, seg, src)
def _pad(x, pw):
    flat = tuple(v for pair in reversed(pw) for v in pair)
    return torch.nn.functional.pad(x, flat)

kernel_name = 'gated_mix__sliding_local_dilated__moe_arch_mod__prompt'

def setup_inputs():

    _w = (lambda a: (lambda t: t.to(torch.bfloat16) if t.is_floating_point() else t)(torch.as_tensor(a)))
    def _A_setup():
        B, S, D = 1, 2048, 640
        return {
            "x": _w((lambda *s: torch.randn(*s, dtype=torch.bfloat16) * 0.05)(B, S, D)),
            "wqkv": _w((lambda *s: torch.randn(*s, dtype=torch.bfloat16) * 0.8)(D, 3 * D)),
            "wo": _w((lambda *s: torch.randn(*s, dtype=torch.bfloat16) * 0.05)(D, D)),
        }
    _A_in = _A_setup()

    def _B_setup():
        B, S, D, F, C = 1, 2048, 640, 1728, 1
        return {
            "x": _w((lambda *s: torch.randn(*s, dtype=torch.bfloat16) * 0.05)(B, S, D)),
            "w_r": _w((lambda *s: torch.randn(*s, dtype=torch.bfloat16) * 1.6)(D)),
            "w_gate": _w((lambda *s: torch.randn(*s, dtype=torch.bfloat16) * 0.4)(D, F)),
            "w_up": _w((lambda *s: torch.randn(*s, dtype=torch.bfloat16) * 0.4)(D, F)),
            "w_down": _w((lambda *s: torch.randn(*s, dtype=torch.bfloat16) * 0.4)(F, D)),
        }
    _B_in = _B_setup()

    return {
        "A_x": _A_in["x"],
        "A_wqkv": _A_in["wqkv"],
        "A_wo": _A_in["wo"],
        "B_x": _B_in["x"],
        "B_w_r": _B_in["w_r"],
        "B_w_gate": _B_in["w_gate"],
        "B_w_up": _B_in["w_up"],
        "B_w_down": _B_in["w_down"],
        "gate_w": _w((lambda *s: torch.randn(*s, dtype=torch.bfloat16) * 0.05)(640) * 16.0),
    }

def reference(A_x, A_wqkv, A_wo, B_x, B_w_r, B_w_gate, B_w_up, B_w_down, gate_w):
    def _A_ref(x, wqkv, wo):
        B, S, D = x.shape
        H = 32; Dh = D // H
        W, dil = 8, 2
        qkv = (lambda x, *d: x.permute(*d))((x @ wqkv).reshape(B, S, 3, H, Dh), 2, 0, 3, 1, 4)
        q, k, v = qkv[0], qkv[1], qkv[2]
        scale = Dh ** -0.5
        pos = torch.arange(S)
        off = torch.arange(W) * dil
        idx = pos[:, None] - off[None, :]
        mask = idx >= 0
        idx_c = torch.where(mask, idx, 0).reshape(-1)
        kg = k[:, :, idx_c, :].reshape(B, H, S, W, Dh)
        vg = v[:, :, idx_c, :].reshape(B, H, S, W, Dh)
        logits = torch.einsum("bhsd,bhswd->bhsw", q, kg) * scale
        logits = torch.where(mask[None, None, :, :], logits, -1e9)
        attn = _softmax(logits, axis=-1)
        o = torch.einsum("bhsw,bhswd->bhsd", attn, vg)
        return (lambda x, *d: x.permute(*d))(o, 0, 2, 1, 3).reshape(B, S, D) @ wo

    def _B_ref(x, w_r, w_gate, w_up, w_down):
        B, S, D = x.shape
        C = 1
        r = x @ w_r
        idx = torch.argsort(-r, axis=-1)[:, :C]
        idx_e = (lambda x, n, axis: torch.repeat_interleave(x, n, dim=axis))(idx.reshape(B, C, 1), D, axis=2)
        x_sel = (lambda x, i, axis: torch.take_along_dim(x, i, dim=axis))(x, idx_e, axis=1)
        g = _silu(x_sel @ w_gate)
        u = x_sel @ w_up
        y = (g * u) @ w_down
        r_sel = _sigmoid((lambda x, i, axis: torch.take_along_dim(x, i, dim=axis))(r, idx, axis=1))
        y = y * r_sel.reshape(B, C, 1)
        b_off = (torch.arange(B) * S).reshape(B, 1)
        flat_idx = (idx + b_off).reshape(B * C)
        zero = (x * 0.0).reshape(B * S, D)
        upd = _scatter_add(zero, flat_idx, y.reshape(B * C, D), axis=0)
        return x + upd.reshape(B, S, D)

    x = A_x
    g = _sigmoid((x * gate_w).sum(-1, keepdims=True))
    a = _A_ref(x, A_wqkv, A_wo)
    b = _B_ref(x, B_w_r, B_w_gate, B_w_up, B_w_down)
    return g * a + (1 - g) * b
```

```asm
; @launch grid=(256,1,1) block=(512,1,1) lds=163840
.amdgcn_target "amdgcn-amd-amdhsa--gfx950"
.text
.globl gated_mix__sliding_local_dilated__moe_arch_mod__prompt_kernel
.p2align 12
.p2align 8
.type gated_mix__sliding_local_dilated__moe_arch_mod__prompt_kernel,@function
gated_mix__sliding_local_dilated__moe_arch_mod__prompt_kernel:
    s_load_dwordx16 s[4:19], s[0:1], 0
    s_load_dwordx8 s[20:27], s[0:1], 64
    s_getpc_b64 s[52:53]
L_pc0:
    s_and_b32 s61, s2, 0xf8
    v_min_u32 v1, 7, v0
    v_add_lshl_u32 v1, v1, s61, 7
    v_min_u32 v1, L_end-L_pc0, v1
    v_cmp_gt_u32 vcc, 64, v0
    s_cbranch_vccz L_nocpf0
    global_load_dword v140, v1, s[52:53]
L_nocpf0:
    v_lshrrev_b32_e64 v1, 6, v0
    s_cmp_ge_u32 s2, 256
    s_cbranch_scc1 L_end
    v_readfirstlane_b32 s52, v1
    v_and_b32_e64 v0, 63, v0
    s_and_b32 s53, s2, 7
    s_lshr_b32 s54, s2, 3
    s_mov_b32 s30, 2621440
    s_mov_b32 s31, 0x20000
    s_mov_b32 s34, 2457600
    s_mov_b32 s35, 0x20000
    s_bfe_u32 s55, s2, 0x10001
    s_cmp_ge_u32 s54, 25
    s_cbranch_scc1 L_aux
    s_mul_i32 s56, s54, 52
    s_lshr_b32 s56, s56, 8
    s_mul_i32 s57, s56, 5
    s_sub_u32 s57, s54, s57
    s_and_b32 s58, s2, 1
    s_mul_i32 s58, s58, 5
    s_add_u32 s58, s58, s56
    s_lshr_b32 s59, s53, 1
    s_mul_i32 s59, s59, 5
    s_add_u32 s59, s59, s57
    s_and_b32 s60, s53, 4
    s_lshl_b32 s60, s60, 7
    s_mul_i32 s61, s57, 104
    s_add_u32 s60, s60, s61
    s_sub_u32 s60, s60, 8
    s_cmp_lt_u32 s52, 4
    s_cbranch_scc1 L_cwave
    s_sub_u32 s64, s52, 4
    v_lshrrev_b32 v1, 3, v0
    v_and_b32 v2, 7, v0
    v_lshrrev_b32 v3, 4, v0
    s_and_b32 s68, s64, 1
    s_lshl_b32 s66, s68, 2
    v_xor_b32 v4, v3, v2
    v_xor_b32 v4, s66, v4
    s_lshl3_add_u32 s67, s64, s60
    s_lshl1_add_u32 s67, s67, s55
    s_mul_i32 s67, s67, 1280
    v_mul_u32_u24 v5, 2560, v1
    v_lshl_add_u32 v5, v4, 4, v5
    v_add_u32 v12, s67, v5
    v_and_b32 v3, 6, v1
    v_xor_b32 v4, v3, v2
    s_lshl_b32 s65, s58, 7
    v_lshl_add_u32 v4, v4, 4, s65
    s_lshl_b32 s68, s68, 4
    s_and_b32 s65, s64, 2
    s_lshl1_add_u32 s68, s65, s68
    v_and_b32 v5, 4, v1
    v_add3_u32 v5, v5, v1, s68
    v_mul_u32_u24 v5, 3840, v5
    v_add_u32_e64 v16, v5, v4
    v_add_u32 v13, 81920, v12
    v_add_u32 v14, 163840, v12
    v_add_u32 v15, 245760, v12
    s_lshl_b32 s67, s64, 10
    s_cmp_ge_u32 s64, 2
    s_cselect_b64 vcc, -1, 0
    s_waitcnt lgkmcnt(0)
    s_mov_b64 s[28:29], s[4:5]
    s_mov_b64 s[32:33], s[6:7]
    s_add_u32 m0, s67, 0
    s_movk_i32 s65, 0
    buffer_load_dwordx4 v12, s[28:31], s65 offen  lds
    s_add_u32 m0, s67, 14336
    s_mov_b32 s66, 0
    buffer_load_dwordx4 v16, s[32:35], s66 offen offset:0  lds
    s_add_u32 m0, s67, 17152
    s_nop 0
    buffer_load_dwordx4 v16, s[32:35], s66 offen offset:1280  lds
    s_add_u32 m0, s67, 4096
    s_nop 0
    buffer_load_dwordx4 v13, s[28:31], s65 offen  lds
    s_add_u32 m0, s67, 19968
    s_nop 0
    buffer_load_dwordx4 v16, s[32:35], s66 offen offset:2560  lds
    s_add_u32 m0, s67, 26624
    s_mov_b32 s66, 122880
    buffer_load_dwordx4 v16, s[32:35], s66 offen offset:0  lds
    s_add_u32 m0, s67, 8192
    s_nop 0
    buffer_load_dwordx4 v14, s[28:31], s65 offen  lds
    s_add_u32 m0, s67, 29440
    s_nop 0
    buffer_load_dwordx4 v16, s[32:35], s66 offen offset:1280  lds
    s_mov_b64 s[36:37], s[8:9]
    s_mov_b64 s[40:41], s[26:27]
    s_mov_b64 s[44:45], s[24:25]
    s_mov_b64 s[48:49], s[22:23]
    s_mov_b32 s38, 819200
    s_mov_b32 s39, 0x20000
    s_mov_b32 s42, 20971520
    s_mov_b32 s43, 0x20000
    s_mov_b32 s46, 256
    s_mov_b32 s47, 0x20000
    s_mov_b32 s50, 2621440
    s_mov_b32 s51, 0x20000
    s_lshl_b32 s68, s64, 3
    v_add_u32 v5, s68, v1
    v_mul_u32_u24 v5, 1280, v5
    v_add_u32_e64 v43, v5, v4
    s_getreg_b32 s84, hwreg(HW_REG_XCC_ID, 0, 3)
    s_lshl_b32 s84, s84, 2
    s_lshl_b32 s84, 1, s84
    s_and_b32 s83, s2, 1
    s_lshl1_add_u32 s83, s59, s83
    s_lshl_b32 s83, s83, 7
    s_add_u32 s83, s83, 5990144
    s_lshl_b32 s53, s59, 8
    s_add_u32 s53, s53, 5990144
    s_add_u32 s21, s53, 128
    s_add_u32 m0, s67, 32256
    s_nop 0
    buffer_load_dwordx4 v16, s[32:35], s66 offen offset:2560  lds
    s_cbranch_vccnz L_skipx_1
    s_add_u32 m0, s67, 12288
    s_nop 0
    buffer_load_dwordx4 v15, s[28:31], s65 offen  lds
L_skipx_1:
    s_add_u32 m0, s67, 77824
    s_movk_i32 s65, 128
    buffer_load_dwordx4 v12, s[28:31], s65 offen  lds
    s_add_u32 m0, s67, 92160
    s_mov_b32 s66, 245760
    buffer_load_dwordx4 v16, s[32:35], s66 offen offset:0  lds
    s_add_u32 m0, s67, 94976
    s_nop 0
    buffer_load_dwordx4 v16, s[32:35], s66 offen offset:1280  lds
    s_add_u32 m0, s67, 81920
    s_nop 0
    buffer_load_dwordx4 v13, s[28:31], s65 offen  lds
    s_add_u32 m0, s67, 97792
    s_nop 0
    buffer_load_dwordx4 v16, s[32:35], s66 offen offset:2560  lds
    s_add_u32 m0, s67, 104448
    s_mov_b32 s66, 368640
    buffer_load_dwordx4 v16, s[32:35], s66 offen offset:0  lds
    s_add_u32 m0, s67, 86016
    s_nop 0
    buffer_load_dwordx4 v14, s[28:31], s65 offen  lds
    s_add_u32 m0, s67, 107264
    s_nop 0
    buffer_load_dwordx4 v16, s[32:35], s66 offen offset:1280  lds
    s_waitcnt vmcnt(8)
    s_barrier
    s_add_u32 m0, s67, 110080
    s_nop 0
    buffer_load_dwordx4 v16, s[32:35], s66 offen offset:2560  lds
    s_cbranch_vccnz L_skipx_2
    s_add_u32 m0, s67, 90112
    s_nop 0
    buffer_load_dwordx4 v15, s[28:31], s65 offen  lds
L_skipx_2:
    s_add_u32 m0, s67, 38912
    s_movk_i32 s65, 256
    buffer_load_dwordx4 v12, s[28:31], s65 offen  lds
    s_add_u32 m0, s67, 53248
    s_mov_b32 s66, 491520
    buffer_load_dwordx4 v16, s[32:35], s66 offen offset:0  lds
    s_add_u32 m0, s67, 56064
    s_nop 0
    buffer_load_dwordx4 v16, s[32:35], s66 offen offset:1280  lds
    s_add_u32 m0, s67, 43008
    s_nop 0
    buffer_load_dwordx4 v13, s[28:31], s65 offen  lds
    s_add_u32 m0, s67, 58880
    s_nop 0
    buffer_load_dwordx4 v16, s[32:35], s66 offen offset:2560  lds
    s_add_u32 m0, s67, 65536
    s_mov_b32 s66, 614400
    buffer_load_dwordx4 v16, s[32:35], s66 offen offset:0  lds
    s_add_u32 m0, s67, 47104
    s_nop 0
    buffer_load_dwordx4 v14, s[28:31], s65 offen  lds
    s_add_u32 m0, s67, 68352
    s_nop 0
    buffer_load_dwordx4 v16, s[32:35], s66 offen offset:1280  lds
    s_waitcnt vmcnt(8)
    s_barrier
    s_add_u32 m0, s67, 71168
    s_nop 0
    buffer_load_dwordx4 v16, s[32:35], s66 offen offset:2560  lds
    s_cbranch_vccnz L_skipx_3
    s_add_u32 m0, s67, 51200
    s_nop 0
    buffer_load_dwordx4 v15, s[28:31], s65 offen  lds
L_skipx_3:
    s_add_u32 m0, s67, 0
    s_movk_i32 s65, 384
    buffer_load_dwordx4 v12, s[28:31], s65 offen  lds
    s_add_u32 m0, s67, 14336
    s_mov_b32 s66, 737280
    buffer_load_dwordx4 v16, s[32:35], s66 offen offset:0  lds
    s_add_u32 m0, s67, 17152
    s_nop 0
    buffer_load_dwordx4 v16, s[32:35], s66 offen offset:1280  lds
    s_add_u32 m0, s67, 4096
    s_nop 0
    buffer_load_dwordx4 v13, s[28:31], s65 offen  lds
    s_add_u32 m0, s67, 19968
    s_nop 0
    buffer_load_dwordx4 v16, s[32:35], s66 offen offset:2560  lds
    s_add_u32 m0, s67, 26624
    s_mov_b32 s66, 860160
    buffer_load_dwordx4 v16, s[32:35], s66 offen offset:0  lds
    s_add_u32 m0, s67, 8192
    s_nop 0
    buffer_load_dwordx4 v14, s[28:31], s65 offen  lds
    s_add_u32 m0, s67, 29440
    s_nop 0
    buffer_load_dwordx4 v16, s[32:35], s66 offen offset:1280  lds
    s_waitcnt vmcnt(8)
    s_barrier
    s_add_u32 m0, s67, 32256
    s_nop 0
    buffer_load_dwordx4 v16, s[32:35], s66 offen offset:2560  lds
    s_cbranch_vccnz L_skipx_4
    s_add_u32 m0, s67, 12288
    s_nop 0
    buffer_load_dwordx4 v15, s[28:31], s65 offen  lds
L_skipx_4:
    s_add_u32 m0, s67, 77824
    s_movk_i32 s65, 512
    buffer_load_dwordx4 v12, s[28:31], s65 offen  lds
    s_add_u32 m0, s67, 92160
    s_mov_b32 s66, 983040
    buffer_load_dwordx4 v16, s[32:35], s66 offen offset:0  lds
    s_add_u32 m0, s67, 94976
    s_nop 0
    buffer_load_dwordx4 v16, s[32:35], s66 offen offset:1280  lds
    s_add_u32 m0, s67, 81920
    s_nop 0
    buffer_load_dwordx4 v13, s[28:31], s65 offen  lds
    s_add_u32 m0, s67, 97792
    s_nop 0
    buffer_load_dwordx4 v16, s[32:35], s66 offen offset:2560  lds
    s_add_u32 m0, s67, 104448
    s_mov_b32 s66, 1105920
    buffer_load_dwordx4 v16, s[32:35], s66 offen offset:0  lds
    s_add_u32 m0, s67, 86016
    s_nop 0
    buffer_load_dwordx4 v14, s[28:31], s65 offen  lds
    s_add_u32 m0, s67, 107264
    s_nop 0
    buffer_load_dwordx4 v16, s[32:35], s66 offen offset:1280  lds
    s_waitcnt vmcnt(8)
    s_barrier
    s_add_u32 m0, s67, 110080
    s_nop 0
    buffer_load_dwordx4 v16, s[32:35], s66 offen offset:2560  lds
    s_cbranch_vccnz L_skipx_5
    s_add_u32 m0, s67, 90112
    s_nop 0
    buffer_load_dwordx4 v15, s[28:31], s65 offen  lds
L_skipx_5:
    s_add_u32 m0, s67, 38912
    s_movk_i32 s65, 640
    buffer_load_dwordx4 v12, s[28:31], s65 offen  lds
    s_add_u32 m0, s67, 53248
    s_mov_b32 s66, 1228800
    buffer_load_dwordx4 v16, s[32:35], s66 offen offset:0  lds
    s_add_u32 m0, s67, 56064
    s_nop 0
    buffer_load_dwordx4 v16, s[32:35], s66 offen offset:1280  lds
    s_add_u32 m0, s67, 43008
    s_nop 0
    buffer_load_dwordx4 v13, s[28:31], s65 offen  lds
    s_add_u32 m0, s67, 58880
    s_nop 0
    buffer_load_dwordx4 v16, s[32:35], s66 offen offset:2560  lds
    s_add_u32 m0, s67, 65536
    s_mov_b32 s66, 1351680
    buffer_load_dwordx4 v16, s[32:35], s66 offen offset:0  lds
    s_add_u32 m0, s67, 47104
    s_nop 0
    buffer_load_dwordx4 v14, s[28:31], s65 offen  lds
    s_add_u32 m0, s67, 68352
    s_nop 0
    buffer_load_dwordx4 v16, s[32:35], s66 offen offset:1280  lds
    s_load_dword s85, s[44:45], 252
    s_waitcnt vmcnt(8)
    s_barrier
    s_add_u32 m0, s67, 71168
    s_nop 0
    buffer_load_dwordx4 v16, s[32:35], s66 offen offset:2560  lds
    s_cbranch_vccnz L_skipx_6
    s_add_u32 m0, s67, 51200
    s_nop 0
    buffer_load_dwordx4 v15, s[28:31], s65 offen  lds
L_skipx_6:
    s_add_u32 m0, s67, 0
    s_movk_i32 s65, 768
    buffer_load_dwordx4 v12, s[28:31], s65 offen  lds
    s_add_u32 m0, s67, 14336
    s_mov_b32 s66, 1474560
    buffer_load_dwordx4 v16, s[32:35], s66 offen offset:0  lds
    s_add_u32 m0, s67, 17152
    s_nop 0
    buffer_load_dwordx4 v16, s[32:35], s66 offen offset:1280  lds
    s_add_u32 m0, s67, 4096
    s_nop 0
    buffer_load_dwordx4 v13, s[28:31], s65 offen  lds
    s_add_u32 m0, s67, 19968
    s_nop 0
    buffer_load_dwordx4 v16, s[32:35], s66 offen offset:2560  lds
    s_add_u32 m0, s67, 26624
    s_mov_b32 s66, 1597440
    buffer_load_dwordx4 v16, s[32:35], s66 offen offset:0  lds
    s_add_u32 m0, s67, 8192
    s_nop 0
    buffer_load_dwordx4 v14, s[28:31], s65 offen  lds
    s_add_u32 m0, s67, 29440
    s_nop 0
    buffer_load_dwordx4 v16, s[32:35], s66 offen offset:1280  lds
    s_waitcnt lgkmcnt(0)
    s_cmp_eq_u32 s85, 0
    s_cbranch_scc1 L_ll_init
L_ll_initok:
    s_cmp_eq_u32 s64, 3
    s_cbranch_scc0 L_ll_na
    s_atomic_add s84, s[40:41], s83
L_ll_na:
    s_waitcnt vmcnt(8)
    s_barrier
    s_add_u32 m0, s67, 32256
    s_nop 0
    buffer_load_dwordx4 v16, s[32:35], s66 offen offset:2560  lds
    s_cbranch_vccnz L_skipx_7
    s_add_u32 m0, s67, 12288
    s_nop 0
    buffer_load_dwordx4 v15, s[28:31], s65 offen  lds
L_skipx_7:
    s_add_u32 m0, s67, 77824
    s_movk_i32 s65, 896
    buffer_load_dwordx4 v12, s[28:31], s65 offen  lds
    s_add_u32 m0, s67, 92160
    s_mov_b32 s66, 1720320
    buffer_load_dwordx4 v16, s[32:35], s66 offen offset:0  lds
    s_add_u32 m0, s67, 94976
    s_nop 0
    buffer_load_dwordx4 v16, s[32:35], s66 offen offset:1280  lds
    s_add_u32 m0, s67, 81920
    s_nop 0
    buffer_load_dwordx4 v13, s[28:31], s65 offen  lds
    s_add_u32 m0, s67, 97792
    s_nop 0
    buffer_load_dwordx4 v16, s[32:35], s66 offen offset:2560  lds
    s_add_u32 m0, s67, 104448
    s_mov_b32 s66, 1843200
    buffer_load_dwordx4 v16, s[32:35], s66 offen offset:0  lds
    s_add_u32 m0, s67, 86016
    s_nop 0
    buffer_load_dwordx4 v14, s[28:31], s65 offen  lds
    s_add_u32 m0, s67, 107264
    s_nop 0
    buffer_load_dwordx4 v16, s[32:35], s66 offen offset:1280  lds
    s_waitcnt vmcnt(8)
    s_barrier
    s_add_u32 m0, s67, 110080
    s_nop 0
    buffer_load_dwordx4 v16, s[32:35], s66 offen offset:2560  lds
    s_cbranch_vccnz L_skipx_8
    s_add_u32 m0, s67, 90112
    s_nop 0
    buffer_load_dwordx4 v15, s[28:31], s65 offen  lds
L_skipx_8:
    s_add_u32 m0, s67, 38912
    s_movk_i32 s65, 1024
    buffer_load_dwordx4 v12, s[28:31], s65 offen  lds
    s_add_u32 m0, s67, 53248
    s_mov_b32 s66, 1966080
    buffer_load_dwordx4 v16, s[32:35], s66 offen offset:0  lds
    s_add_u32 m0, s67, 56064
    s_nop 0
    buffer_load_dwordx4 v16, s[32:35], s66 offen offset:1280  lds
    s_add_u32 m0, s67, 43008
    s_nop 0
    buffer_load_dwordx4 v13, s[28:31], s65 offen  lds
    s_add_u32 m0, s67, 58880
    s_nop 0
    buffer_load_dwordx4 v16, s[32:35], s66 offen offset:2560  lds
    s_add_u32 m0, s67, 65536
    s_mov_b32 s66, 2088960
    buffer_load_dwordx4 v16, s[32:35], s66 offen offset:0  lds
    s_add_u32 m0, s67, 47104
    s_nop 0
    buffer_load_dwordx4 v14, s[28:31], s65 offen  lds
    s_add_u32 m0, s67, 68352
    s_nop 0
    buffer_load_dwordx4 v16, s[32:35], s66 offen offset:1280  lds
    s_waitcnt vmcnt(8)
    s_barrier
    s_add_u32 m0, s67, 71168
    s_nop 0
    buffer_load_dwordx4 v16, s[32:35], s66 offen offset:2560  lds
    s_cbranch_vccnz L_skipx_9
    s_add_u32 m0, s67, 51200
    s_nop 0
    buffer_load_dwordx4 v15, s[28:31], s65 offen  lds
L_skipx_9:
    s_add_u32 m0, s67, 0
    s_movk_i32 s65, 1152
    buffer_load_dwordx4 v12, s[28:31], s65 offen  lds
    s_add_u32 m0, s67, 14336
    s_mov_b32 s66, 2211840
    buffer_load_dwordx4 v16, s[32:35], s66 offen offset:0  lds
    s_add_u32 m0, s67, 17152
    s_nop 0
    buffer_load_dwordx4 v16, s[32:35], s66 offen offset:1280  lds
    s_add_u32 m0, s67, 4096
    s_nop 0
    buffer_load_dwordx4 v13, s[28:31], s65 offen  lds
    s_add_u32 m0, s67, 19968
    s_nop 0
    buffer_load_dwordx4 v16, s[32:35], s66 offen offset:2560  lds
    s_add_u32 m0, s67, 26624
    s_mov_b32 s66, 2334720
    buffer_load_dwordx4 v16, s[32:35], s66 offen offset:0  lds
    s_add_u32 m0, s67, 8192
    s_nop 0
    buffer_load_dwordx4 v14, s[28:31], s65 offen  lds
    s_add_u32 m0, s67, 29440
    s_nop 0
    buffer_load_dwordx4 v16, s[32:35], s66 offen offset:1280  lds
    s_load_dword s0, s[40:41], s53
    s_load_dword s1, s[40:41], s21
    s_waitcnt vmcnt(8)
    s_barrier
    s_add_u32 m0, s67, 32256
    s_nop 0
    buffer_load_dwordx4 v16, s[32:35], s66 offen offset:2560  lds
    s_cbranch_vccnz L_skipx_10
    s_add_u32 m0, s67, 12288
    s_nop 0
    buffer_load_dwordx4 v15, s[28:31], s65 offen  lds
L_skipx_10:
    s_add_u32 s67, s67, 81920
    s_sub_u32 s65, s58, s56
    s_mul_i32 s65, s65, 81920
    s_add_u32 s66, s56, 0
    s_cmp_ge_u32 s66, 5
    s_cselect_b32 s68, 5, 0
    s_sub_u32 s66, s66, s68
    s_mul_i32 s66, s66, 81920
    s_add_u32 m0, s67, 0
    s_add_u32 s66, s66, s65
    buffer_load_dwordx4 v43, s[36:39], s66 offen lds
    s_add_u32 m0, s67, 4096
    s_add_u32 s66, s66, 40960
    buffer_load_dwordx4 v43, s[36:39], s66 offen lds
    s_cmp_lt_u32 s56, 1
    s_cselect_b32 s66, 1, 0
    s_mul_i32 s66, s66, 81920
    s_add_u32 m0, s67, 8192
    s_add_u32 s66, s66, s65
    buffer_load_dwordx4 v43, s[36:39], s66 offen lds
    s_add_u32 m0, s67, 12288
    s_add_u32 s66, s66, 40960
    buffer_load_dwordx4 v43, s[36:39], s66 offen lds
    s_cmp_lt_u32 s56, 2
    s_cselect_b32 s66, 2, 1
    s_mul_i32 s66, s66, 81920
    s_add_u32 m0, s67, 16384
    s_add_u32 s66, s66, s65
    buffer_load_dwordx4 v43, s[36:39], s66 offen lds
    s_add_u32 m0, s67, 20480
    s_add_u32 s66, s66, 40960
    buffer_load_dwordx4 v43, s[36:39], s66 offen lds
    s_cmp_lt_u32 s56, 3
    s_cselect_b32 s66, 3, 2
    s_mul_i32 s66, s66, 81920
    s_add_u32 m0, s67, 24576
    s_add_u32 s66, s66, s65
    buffer_load_dwordx4 v43, s[36:39], s66 offen lds
    s_waitcnt vmcnt(7)
    s_barrier
    s_add_u32 m0, s67, 28672
    s_add_u32 s66, s66, 40960
    buffer_load_dwordx4 v43, s[36:39], s66 offen lds
    s_cmp_lt_u32 s56, 4
    s_cselect_b32 s66, 4, 3
    s_mul_i32 s66, s66, 81920
    s_add_u32 m0, s67, 32768
    s_add_u32 s66, s66, s65
    buffer_load_dwordx4 v43, s[36:39], s66 offen lds
    s_add_u32 m0, s67, 36864
    s_add_u32 s66, s66, 40960
    buffer_load_dwordx4 v43, s[36:39], s66 offen lds
    s_sub_u32 s65, 409600, s65
    s_mov_b32 s66, 0
    s_mul_i32 s66, s66, 81920
    s_add_u32 m0, s67, 40960
    s_add_u32 s66, s66, s65
    buffer_load_dwordx4 v43, s[36:39], s66 offen lds
    s_add_u32 m0, s67, 45056
    s_add_u32 s66, s66, 40960
    buffer_load_dwordx4 v43, s[36:39], s66 offen lds
    s_branch L_lpost
    s_nop 0
L_ll_init:
    v_mov_b32 v6, 252
    s_mov_b32 s61, 0
L_ll_init2:
    buffer_load_dword v7, v6, s[44:47], 0 offen sc1
    s_add_u32 s61, s61, 1
    s_waitcnt vmcnt(0)
    v_readfirstlane_b32 s85, v7
    s_cmp_lt_u32 s61, 30000
    s_cbranch_scc0 L_ll_initok
    s_cmp_eq_u32 s85, 0
    s_cbranch_scc0 L_ll_initok
    s_sleep 4
    s_branch L_ll_init2
.p2align 12
L_cwave:
    v_and_b32 v1, 15, v0
    v_lshrrev_b32 v2, 4, v0
    v_mov_b32 v88, 0
    v_mov_b32 v89, 0
    v_mov_b32 v90, 0
    v_mov_b32 v91, 0
    v_lshlrev_b32 v12, 7, v0
    s_waitcnt lgkmcnt(0)
    s_mov_b64 s[28:29], s[4:5]
    s_mov_b64 s[32:33], s[6:7]
    s_mov_b64 s[36:37], s[8:9]
    s_mov_b64 s[40:41], s[26:27]
    s_mov_b64 s[44:45], s[24:25]
    s_mov_b64 s[48:49], s[22:23]
    s_mov_b32 s38, 819200
    s_mov_b32 s39, 0x20000
    s_mov_b32 s42, 20971520
    s_mov_b32 s43, 0x20000
    s_mov_b32 s46, 256
    s_mov_b32 s47, 0x20000
    s_mov_b32 s50, 2621440
    s_mov_b32 s51, 0x20000
    s_mul_i32 s20, s59, 1136
    s_add_u32 s20, s20, s58
    s_lshl_b32 s20, s20, 8
    s_add_u32 s20, s20, 286720
    s_mul_i32 s54, s58, 14336
    s_mul_i32 s63, s59, 290816
    s_add_u32 s54, s54, s63
    s_cmp_eq_u32 s52, 0
    s_cbranch_scc0 L_ch1
    s_mov_b64 exec, 3
    buffer_store_dwordx4 v[88:91], v12, s[40:43], s20 offen sc1
    s_branch L_ch3
L_ch1:
    s_cmp_eq_u32 s52, 3
    s_cbranch_scc0 L_ch3
    s_max_i32 s63, s60, 0
    s_mul_i32 s63, s63, 2560
    v_mul_u32_u24 v13, 256000, v0
    s_mov_b64 exec, 3
    buffer_load_dword v128, v13, s[48:51], s63 offen sc1
L_ch3:
    s_mov_b64 exec, -1
    s_add_u32 s74, s52, 5
    s_sub_u32 s74, s74, s56
    s_cmp_ge_u32 s74, 5
    s_cselect_b32 s63, 5, 0
    s_sub_u32 s74, s74, s63
    s_cmp_gt_u32 s52, s56
    s_subb_u32 s82, s52, 0
    s_cmp_lt_u32 s52, s56
    s_addc_u32 s83, s52, 0
    s_cmp_eq_u32 s74, 0
    s_cselect_b32 s82, s83, s82
    s_cmp_eq_u32 s74, 4
    s_cselect_b32 s83, s82, s83
    s_cmp_eq_u32 s82, 0
    s_cselect_b32 s84, 0x204, 4
    s_cmp_eq_u32 s83, 3
    s_cselect_b32 s84, 0x20004, s84
    s_mul_i32 s82, s82, 7168
    s_mul_i32 s83, s83, 7168
    s_add_u32 s82, s82, 131072
    s_add_u32 s83, s83, 131072
    v_cmp_gt_u32 vcc, s74, v2
    v_lshrrev_b32_e64 v12, 2, v1
    v_cmp_gt_u32 s[66:67], s74, v12
    s_cmp_eq_u32 s52, 3
    s_cselect_b64 s[64:65], -1, 0
    s_cselect_b32 s63, 2, -1
    s_cselect_b32 s79, 508, 0
    s_xor_b64 s[64:65], s[64:65], vcc
    s_mul_i32 s80, s63, 7168
    s_add_u32 s80, s80, s54
    s_add_u32 s81, s20, s79
    s_sub_u32 s81, s81, 252
    s_add_u32 s61, s52, 1
    s_and_b32 s61, s61, 2
    s_cselect_b32 s81, 0, s81
    s_cmp_eq_u64 s[64:65], 0
    s_cselect_b32 s81, 0, s81
    s_lshr_b32 s79, s52, 1
    s_mul_i32 s63, s79, 7168
    s_add_u32 s54, s54, s63
    s_and_b32 s63, s52, 1
    s_lshl_b32 s63, s63, 9
    s_add_u32 s54, s54, s63
    s_add_u32 s75, s79, 1
    s_and_b32 s61, s52, 1
    s_mul_i32 s61, s61, 1536
    s_mul_i32 s63, s75, 7168
    s_lshl1_add_u32 s63, s61, s63
    s_add_u32 s63, s63, 131080
    v_lshlrev_b32 v255, 4, v0
    v_lshrrev_b32_e64 v8, 2, v0
    v_bfi_b32 v8, v0, 0, v8
    v_and_b32 v8, 8, v8
    v_sub_u32 v8, v255, v8
    v_add_u32 v254, s63, v8
    s_mul_i32 s63, s75, 5
    s_sub_u32 s63, s63, s56
    s_add_u32 s63, s63, 4
    s_add_u32 s61, s61, 38912
    v_and_b32_e64 v9, 15, v0
    v_lshl_add_u32 v10, v9, 3, s61
    v_lshrrev_b32 v11, 4, v0
    v_add_u32 v8, s63, v11
    v_lshl_add_u32 v251, v8, 7, v10
    v_lshrrev_b32_e64 v8, 2, v8
    v_mul_u32_u24 v8, 6656, v8
    v_add_u32_e64 v251, v251, v8
    s_add_u32 s63, s63, 4
    s_lshr_b32 s62, s63, 2
    s_mul_i32 s62, s62, 6656
    s_lshl_b32 s63, s63, 7
    s_add_u32 s63, s63, s62
    v_add_u32 v252, s63, v10
    v_lshlrev_b32 v8, 2, v11
    v_sub_u32_e64 v9, v9, v8
    v_mov_b32 v11, 0xf149f2ca
    v_subrev_u32 v10, 0, v9
    v_and_b32 v10, 8, v10
    v_cmp_eq_u32 vcc, 0, v10
    s_nop 1
    v_cndmask_b32_e64 v240, v11, v10, vcc
    v_subrev_u32 v10, 1, v9
    v_and_b32 v10, 8, v10
    v_cmp_eq_u32 vcc, 0, v10
    s_nop 1
    v_cndmask_b32_e64 v241, v11, v10, vcc
    v_subrev_u32 v10, 2, v9
    v_and_b32 v10, 8, v10
    v_cmp_eq_u32 vcc, 0, v10
    s_nop 1
    v_cndmask_b32_e64 v242, v11, v10, vcc
    v_subrev_u32 v10, 3, v9
    v_and_b32 v10, 8, v10
    v_cmp_eq_u32 vcc, 0, v10
    s_nop 1
    v_cndmask_b32_e64 v243, v11, v10, vcc
    s_cmp_lt_i32 s60, 0
    s_cselect_b32 s63, 32, 0
    s_bitcmp1_b32 s52, 0
    s_cselect_b32 s63, 0, s63
    v_cmp_gt_u32 vcc, s63, v0
    s_nop 1
    v_cndmask_b32_e64 v244, v240, v11, vcc
    v_cndmask_b32_e64 v245, v241, v11, vcc
    v_cndmask_b32_e64 v246, v242, v11, vcc
    v_cndmask_b32_e64 v247, v243, v11, vcc
    s_lshl_b32 s63, s52, 13
    s_add_u32 s63, s63, 131072
    v_add_u32 v8, s63, v255
    ds_write_b128 v8, v[88:91] offset:0
    ds_write_b128 v8, v[88:91] offset:1024
    ds_write_b128 v8, v[88:91] offset:2048
    ds_write_b128 v8, v[88:91] offset:3072
    ds_write_b128 v8, v[88:91] offset:4096
    ds_write_b128 v8, v[88:91] offset:5120
    ds_write_b128 v8, v[88:91] offset:6144
    ds_write_b128 v8, v[88:91] offset:7168
    s_and_b32 s63, s2, 1
    s_xor_b32 s63, s63, 1
    s_mul_i32 s63, s63, 1280
    s_mul_i32 s72, s59, 290816
    s_add_u32 s72, s72, s63
    s_add_u32 s72, s72, s40
    s_addc_u32 s73, s41, 0
    s_mov_b32 s78, 1
    v_lshrrev_b32 v8, 1, v1
    v_xor_b32 v9, v8, v2
    v_lshlrev_b32_e64 v9, 4, v9
    v_lshl_add_u32 v248, v1, 7, v9
    v_xor_b32_e64 v249, 64, v248
    v_bfe_u32 v9, v0, 3, 2
    v_xor_b32 v9, s52, v9
    v_lshlrev_b32 v9, 5, v9
    v_and_b32_e64 v10, 3, v0
    v_lshl_add_u32 v9, v10, 3, v9
    v_lshrrev_b32_e64 v10, 2, v0
    v_lshl_add_u32 v9, v10, 7, v9
    v_add_u32 v250, 14336, v9
    v_bfe_u32 v8, v0, 1, 3
    v_lshrrev_b32 v9, 5, v0
    v_xor_b32 v9, v9, v8
    v_lshlrev_b32_e64 v9, 4, v9
    v_bfe_u32 v10, v0, 4, 1
    v_lshl_add_u32 v9, v10, 3, v9
    v_and_b32_e64 v10, 15, v0
    v_lshl_add_u32 v9, v10, 7, v9
    s_mul_i32 s61, s58, 86
    s_lshr_b32 s61, s61, 8
    s_mul_i32 s61, s61, 3
    s_sub_u32 s61, s58, s61
    s_sub_u32 s62, 3, s61
    s_cmp_eq_u32 s61, 0
    s_cselect_b32 s62, 0, s62
    s_mul_i32 s62, s62, 38912
    s_lshl_b32 s63, s52, 12
    s_add_u32 s63, s63, s62
    v_add_u32_e64 v3, s63, v9
    v_mfma_f32_16x16x32_bf16 v[168:171], v[88:91], v[88:91], 0
    v_mfma_f32_16x16x32_bf16 v[172:175], v[88:91], v[88:91], 0
    v_mfma_f32_16x16x32_bf16 v[176:179], v[88:91], v[88:91], 0
    v_mfma_f32_16x16x32_bf16 v[180:183], v[88:91], v[88:91], 0
    v_mfma_f32_16x16x32_bf16 v[184:187], v[88:91], v[88:91], 0
    v_mfma_f32_16x16x32_bf16 v[188:191], v[88:91], v[88:91], 0
    v_mfma_f32_16x16x32_bf16 v[192:195], v[88:91], v[88:91], 0
    v_mfma_f32_16x16x32_bf16 v[196:199], v[88:91], v[88:91], 0
    v_mfma_f32_16x16x32_bf16 v[200:203], v[88:91], v[88:91], 0
    v_mfma_f32_16x16x32_bf16 v[204:207], v[88:91], v[88:91], 0
    v_mfma_f32_16x16x32_bf16 v[208:211], v[88:91], v[88:91], 0
    v_mfma_f32_16x16x32_bf16 v[212:215], v[88:91], v[88:91], 0
    v_mfma_f32_16x16x32_bf16 v[216:219], v[88:91], v[88:91], 0
    v_mfma_f32_16x16x32_bf16 v[220:223], v[88:91], v[88:91], 0
    v_mfma_f32_16x16x32_bf16 v[224:227], v[88:91], v[88:91], 0
    v_mfma_f32_16x16x32_bf16 v[228:231], v[88:91], v[88:91], 0
    s_mov_b64 exec, 0
    s_cmp_eq_u32 s52, 0
    s_cbranch_scc1 L_pg1
    s_cmp_eq_u32 s52, 1
    s_cbranch_scc1 L_pg2
    s_cmp_eq_u32 s52, 2
    s_cbranch_scc1 L_pg3
    s_branch L_pg4
L_hopret:
    s_mov_b64 exec, -1
    s_cmp_eq_u32 s52, 0
    s_cbranch_scc0 L_ch4
    v_mov_b32_e64 v1, s20
    s_waitcnt vmcnt(0)
    buffer_load_dword v2, v1, s[40:43], 0 offen sc1
    s_branch L_ch5
L_ch4:
    s_waitcnt vmcnt(0)
L_ch5:
    s_lshl_b32 s63, s52, 13
    s_add_u32 s63, s63, 131072
    v_add_u32_e64 v1, s63, v255
    s_barrier
    ds_read_b64_tr_b16 v[116:117], v250 offset:0
    ds_read_b64_tr_b16 v[118:119], v250 offset:2048
    ds_read_b64_tr_b16 v[120:121], v250 offset:4096
    ds_read_b64_tr_b16 v[122:123], v250 offset:6144
    ds_read_b64_tr_b16 v[124:125], v250 offset:8192
    ds_read_b64_tr_b16 v[126:127], v250 offset:10240
    ds_read_b128 v[88:91], v248 offset:0
    ds_read_b128 v[92:95], v248 offset:2048
    ds_read_b128 v[96:99], v248 offset:4096
    ds_read_b128 v[100:103], v248 offset:6144
    ds_read_b128 v[104:107], v248 offset:8192
    ds_read_b128 v[108:111], v248 offset:10240
    ds_read_b128 v[112:115], v248 offset:12288
    s_waitcnt lgkmcnt(0)
    v_mfma_f32_16x16x32_bf16 v[4:7], v[116:119], v[88:91], 0
    ds_read_b64_tr_b16 v[156:157], v250 offset:12288
    v_mfma_f32_16x16x32_bf16 v[32:35], v[120:123], v[88:91], 0
    ds_read_b64_tr_b16 v[158:159], v250 offset:14336
    v_mfma_f32_16x16x32_bf16 v[60:63], v[88:91], v[124:127], 0
    ds_read_b64_tr_b16 v[160:161], v250 offset:16384
    v_mfma_f32_16x16x32_bf16 v[8:11], v[116:119], v[92:95], 0
    ds_read_b64_tr_b16 v[162:163], v250 offset:18432
    v_mfma_f32_16x16x32_bf16 v[36:39], v[120:123], v[92:95], 0
    ds_read_b64_tr_b16 v[164:165], v250 offset:20480
    v_mfma_f32_16x16x32_bf16 v[64:67], v[92:95], v[124:127], 0
    ds_read_b64_tr_b16 v[166:167], v250 offset:22528
    v_mfma_f32_16x16x32_bf16 v[12:15], v[116:119], v[96:99], 0
    ds_read_b128 v[128:131], v249 offset:0
    v_mfma_f32_16x16x32_bf16 v[40:43], v[120:123], v[96:99], 0
    ds_read_b128 v[132:135], v249 offset:2048
    v_mfma_f32_16x16x32_bf16 v[68:71], v[96:99], v[124:127], 0
    ds_read_b128 v[136:139], v249 offset:4096
    v_mfma_f32_16x16x32_bf16 v[16:19], v[116:119], v[100:103], 0
    ds_read_b128 v[140:143], v249 offset:6144
    v_mfma_f32_16x16x32_bf16 v[44:47], v[120:123], v[100:103], 0
    ds_read_b128 v[144:147], v249 offset:8192
    v_mfma_f32_16x16x32_bf16 v[72:75], v[100:103], v[124:127], 0
    ds_read_b128 v[148:151], v249 offset:10240
    v_mfma_f32_16x16x32_bf16 v[20:23], v[116:119], v[104:107], 0
    ds_read_b128 v[152:155], v249 offset:12288
    v_mfma_f32_16x16x32_bf16 v[48:51], v[120:123], v[104:107], 0
    s_cmp_eq_u32 s58, 0
    s_cbranch_scc1 L_xres_0
L_xret_0:
    v_mfma_f32_16x16x32_bf16 v[76:79], v[104:107], v[124:127], 0
    v_add_u32 v248, 77824, v248
    v_mfma_f32_16x16x32_bf16 v[24:27], v[116:119], v[108:111], 0
    v_add_u32 v249, 77824, v249
    v_mfma_f32_16x16x32_bf16 v[52:55], v[120:123], v[108:111], 0
    v_add_u32 v250, 77824, v250
    v_mfma_f32_16x16x32_bf16 v[80:83], v[108:111], v[124:127], 0
    v_mfma_f32_16x16x32_bf16 v[28:31], v[116:119], v[112:115], 0
    v_mfma_f32_16x16x32_bf16 v[56:59], v[120:123], v[112:115], 0
    v_mfma_f32_16x16x32_bf16 v[84:87], v[112:115], v[124:127], 0
    s_waitcnt lgkmcnt(0)
    v_mfma_f32_16x16x32_bf16 v[4:7], v[156:159], v[128:131], v[4:7]
    s_barrier
    v_mfma_f32_16x16x32_bf16 v[32:35], v[160:163], v[128:131], v[32:35]
    ds_read_b64_tr_b16 v[116:117], v250 offset:0
    v_mfma_f32_16x16x32_bf16 v[60:63], v[128:131], v[164:167], v[60:63]
    ds_read_b64_tr_b16 v[118:119], v250 offset:2048
    v_mfma_f32_16x16x32_bf16 v[8:11], v[156:159], v[132:135], v[8:11]
    ds_read_b64_tr_b16 v[120:121], v250 offset:4096
    v_mfma_f32_16x16x32_bf16 v[36:39], v[160:163], v[132:135], v[36:39]
    ds_read_b64_tr_b16 v[122:123], v250 offset:6144
    v_mfma_f32_16x16x32_bf16 v[64:67], v[132:135], v[164:167], v[64:67]
    ds_read_b64_tr_b16 v[124:125], v250 offset:8192
    v_mfma_f32_16x16x32_bf16 v[12:15], v[156:159], v[136:139], v[12:15]
    ds_read_b64_tr_b16 v[126:127], v250 offset:10240
    v_mfma_f32_16x16x32_bf16 v[40:43], v[160:163], v[136:139], v[40:43]
    ds_read_b128 v[88:91], v248 offset:0
    v_mfma_f32_16x16x32_bf16 v[68:71], v[136:139], v[164:167], v[68:71]
    ds_read_b128 v[92:95], v248 offset:2048
    v_mfma_f32_16x16x32_bf16 v[16:19], v[156:159], v[140:143], v[16:19]
    ds_read_b128 v[96:99], v248 offset:4096
    v_mfma_f32_16x16x32_bf16 v[44:47], v[160:163], v[140:143], v[44:47]
    ds_read_b128 v[100:103], v248 offset:6144
    v_mfma_f32_16x16x32_bf16 v[72:75], v[140:143], v[164:167], v[72:75]
    ds_read_b128 v[104:107], v248 offset:8192
    v_mfma_f32_16x16x32_bf16 v[20:23], v[156:159], v[144:147], v[20:23]
    ds_read_b128 v[108:111], v248 offset:10240
    v_mfma_f32_16x16x32_bf16 v[48:51], v[160:163], v[144:147], v[48:51]
    ds_read_b128 v[112:115], v248 offset:12288
    v_mfma_f32_16x16x32_bf16 v[76:79], v[144:147], v[164:167], v[76:79]
    v_mfma_f32_16x16x32_bf16 v[24:27], v[156:159], v[148:151], v[24:27]
    v_mfma_f32_16x16x32_bf16 v[52:55], v[160:163], v[148:151], v[52:55]
    v_mfma_f32_16x16x32_bf16 v[80:83], v[148:151], v[164:167], v[80:83]
    v_mfma_f32_16x16x32_bf16 v[28:31], v[156:159], v[152:155], v[28:31]
    v_mfma_f32_16x16x32_bf16 v[56:59], v[160:163], v[152:155], v[56:59]
    v_mfma_f32_16x16x32_bf16 v[84:87], v[152:155], v[164:167], v[84:87]
    s_waitcnt lgkmcnt(0)
    v_mfma_f32_16x16x32_bf16 v[4:7], v[116:119], v[88:91], v[4:7]
    ds_read_b64_tr_b16 v[156:157], v250 offset:12288
    v_mfma_f32_16x16x32_bf16 v[32:35], v[120:123], v[88:91], v[32:35]
    ds_read_b64_tr_b16 v[158:159], v250 offset:14336
    v_mfma_f32_16x16x32_bf16 v[60:63], v[88:91], v[124:127], v[60:63]
    ds_read_b64_tr_b16 v[160:161], v250 offset:16384
    v_mfma_f32_16x16x32_bf16 v[8:11], v[116:119], v[92:95], v[8:11]
    ds_read_b64_tr_b16 v[162:163], v250 offset:18432
    v_mfma_f32_16x16x32_bf16 v[36:39], v[120:123], v[92:95], v[36:39]
    ds_read_b64_tr_b16 v[164:165], v250 offset:20480
    v_mfma_f32_16x16x32_bf16 v[64:67], v[92:95], v[124:127], v[64:67]
    ds_read_b64_tr_b16 v[166:167], v250 offset:22528
    v_mfma_f32_16x16x32_bf16 v[12:15], v[116:119], v[96:99], v[12:15]
    ds_read_b128 v[128:131], v249 offset:0
    v_mfma_f32_16x16x32_bf16 v[40:43], v[120:123], v[96:99], v[40:43]
    ds_read_b128 v[132:135], v249 offset:2048
    v_mfma_f32_16x16x32_bf16 v[68:71], v[96:99], v[124:127], v[68:71]
    ds_read_b128 v[136:139], v249 offset:4096
    v_mfma_f32_16x16x32_bf16 v[16:19], v[116:119], v[100:103], v[16:19]
    ds_read_b128 v[140:143], v249 offset:6144
    v_mfma_f32_16x16x32_bf16 v[44:47], v[120:123], v[100:103], v[44:47]
    ds_read_b128 v[144:147], v249 offset:8192
    v_mfma_f32_16x16x32_bf16 v[72:75], v[100:103], v[124:127], v[72:75]
    ds_read_b128 v[148:151], v249 offset:10240
    v_mfma_f32_16x16x32_bf16 v[20:23], v[116:119], v[104:107], v[20:23]
    ds_read_b128 v[152:155], v249 offset:12288
    v_mfma_f32_16x16x32_bf16 v[48:51], v[120:123], v[104:107], v[48:51]
    s_cmp_eq_u32 s58, 1
    s_cbranch_scc1 L_xres_1
L_xret_1:
    v_mfma_f32_16x16x32_bf16 v[76:79], v[104:107], v[124:127], v[76:79]
    v_add_u32 v248, 4294928384, v248
    v_mfma_f32_16x16x32_bf16 v[24:27], v[116:119], v[108:111], v[24:27]
    v_add_u32 v249, 4294928384, v249
    v_mfma_f32_16x16x32_bf16 v[52:55], v[120:123], v[108:111], v[52:55]
    v_add_u32 v250, 4294928384, v250
    v_mfma_f32_16x16x32_bf16 v[80:83], v[108:111], v[124:127], v[80:83]
    v_mfma_f32_16x16x32_bf16 v[28:31], v[116:119], v[112:115], v[28:31]
    v_mfma_f32_16x16x32_bf16 v[56:59], v[120:123], v[112:115], v[56:59]
    v_mfma_f32_16x16x32_bf16 v[84:87], v[112:115], v[124:127], v[84:87]
    s_waitcnt lgkmcnt(0)
    v_mfma_f32_16x16x32_bf16 v[4:7], v[156:159], v[128:131], v[4:7]
    s_barrier
    v_mfma_f32_16x16x32_bf16 v[32:35], v[160:163], v[128:131], v[32:35]
    ds_read_b64_tr_b16 v[116:117], v250 offset:0
    v_mfma_f32_16x16x32_bf16 v[60:63], v[128:131], v[164:167], v[60:63]
    ds_read_b64_tr_b16 v[118:119], v250 offset:2048
    v_mfma_f32_16x16x32_bf16 v[8:11], v[156:159], v[132:135], v[8:11]
    ds_read_b64_tr_b16 v[120:121], v250 offset:4096
    v_mfma_f32_16x16x32_bf16 v[36:39], v[160:163], v[132:135], v[36:39]
    ds_read_b64_tr_b16 v[122:123], v250 offset:6144
    v_mfma_f32_16x16x32_bf16 v[64:67], v[132:135], v[164:167], v[64:67]
    ds_read_b64_tr_b16 v[124:125], v250 offset:8192
    v_mfma_f32_16x16x32_bf16 v[12:15], v[156:159], v[136:139], v[12:15]
    ds_read_b64_tr_b16 v[126:127], v250 offset:10240
    v_mfma_f32_16x16x32_bf16 v[40:43], v[160:163], v[136:139], v[40:43]
    ds_read_b128 v[88:91], v248 offset:0
    v_mfma_f32_16x16x32_bf16 v[68:71], v[136:139], v[164:167], v[68:71]
    ds_read_b128 v[92:95], v248 offset:2048
    v_mfma_f32_16x16x32_bf16 v[16:19], v[156:159], v[140:143], v[16:19]
    ds_read_b128 v[96:99], v248 offset:4096
    v_mfma_f32_16x16x32_bf16 v[44:47], v[160:163], v[140:143], v[44:47]
    ds_read_b128 v[100:103], v248 offset:6144
    v_mfma_f32_16x16x32_bf16 v[72:75], v[140:143], v[164:167], v[72:75]
    ds_read_b128 v[104:107], v248 offset:8192
    v_mfma_f32_16x16x32_bf16 v[20:23], v[156:159], v[144:147], v[20:23]
    ds_read_b128 v[108:111], v248 offset:10240
    v_mfma_f32_16x16x32_bf16 v[48:51], v[160:163], v[144:147], v[48:51]
    ds_read_b128 v[112:115], v248 offset:12288
    v_mfma_f32_16x16x32_bf16 v[76:79], v[144:147], v[164:167], v[76:79]
    v_mfma_f32_16x16x32_bf16 v[24:27], v[156:159], v[148:151], v[24:27]
    v_mfma_f32_16x16x32_bf16 v[52:55], v[160:163], v[148:151], v[52:55]
    v_mfma_f32_16x16x32_bf16 v[80:83], v[148:151], v[164:167], v[80:83]
    v_mfma_f32_16x16x32_bf16 v[28:31], v[156:159], v[152:155], v[28:31]
    v_mfma_f32_16x16x32_bf16 v[56:59], v[160:163], v[152:155], v[56:59]
    v_mfma_f32_16x16x32_bf16 v[84:87], v[152:155], v[164:167], v[84:87]
    s_waitcnt lgkmcnt(0)
    v_mfma_f32_16x16x32_bf16 v[4:7], v[116:119], v[88:91], v[4:7]
    ds_read_b64_tr_b16 v[156:157], v250 offset:12288
    v_mfma_f32_16x16x32_bf16 v[32:35], v[120:123], v[88:91], v[32:35]
    ds_read_b64_tr_b16 v[158:159], v250 offset:14336
    v_mfma_f32_16x16x32_bf16 v[60:63], v[88:91], v[124:127], v[60:63]
    ds_read_b64_tr_b16 v[160:161], v250 offset:16384
    v_mfma_f32_16x16x32_bf16 v[8:11], v[116:119], v[92:95], v[8:11]
    ds_read_b64_tr_b16 v[162:163], v250 offset:18432
    v_mfma_f32_16x16x32_bf16 v[36:39], v[120:123], v[92:95], v[36:39]
    ds_read_b64_tr_b16 v[164:165], v250 offset:20480
    v_mfma_f32_16x16x32_bf16 v[64:67], v[92:95], v[124:127], v[64:67]
    ds_read_b64_tr_b16 v[166:167], v250 offset:22528
    v_mfma_f32_16x16x32_bf16 v[12:15], v[116:119], v[96:99], v[12:15]
    ds_read_b128 v[128:131], v249 offset:0
    v_mfma_f32_16x16x32_bf16 v[40:43], v[120:123], v[96:99], v[40:43]
    ds_read_b128 v[132:135], v249 offset:2048
    v_mfma_f32_16x16x32_bf16 v[68:71], v[96:99], v[124:127], v[68:71]
    ds_read_b128 v[136:139], v249 offset:4096
    v_mfma_f32_16x16x32_bf16 v[16:19], v[116:119], v[100:103], v[16:19]
    ds_read_b128 v[140:143], v249 offset:6144
    v_mfma_f32_16x16x32_bf16 v[44:47], v[120:123], v[100:103], v[44:47]
    ds_read_b128 v[144:147], v249 offset:8192
    v_mfma_f32_16x16x32_bf16 v[72:75], v[100:103], v[124:127], v[72:75]
    ds_read_b128 v[148:151], v249 offset:10240
    v_mfma_f32_16x16x32_bf16 v[20:23], v[116:119], v[104:107], v[20:23]
    ds_read_b128 v[152:155], v249 offset:12288
    v_mfma_f32_16x16x32_bf16 v[48:51], v[120:123], v[104:107], v[48:51]
    s_cmp_eq_u32 s58, 2
    s_cbranch_scc1 L_xres_2
L_xret_2:
    v_mfma_f32_16x16x32_bf16 v[76:79], v[104:107], v[124:127], v[76:79]
    v_add_u32 v248, 4294928384, v248
    v_mfma_f32_16x16x32_bf16 v[24:27], v[116:119], v[108:111], v[24:27]
    v_add_u32 v249, 4294928384, v249
    v_mfma_f32_16x16x32_bf16 v[52:55], v[120:123], v[108:111], v[52:55]
    v_add_u32 v250, 4294928384, v250
    v_mfma_f32_16x16x32_bf16 v[80:83], v[108:111], v[124:127], v[80:83]
    v_mfma_f32_16x16x32_bf16 v[28:31], v[116:119], v[112:115], v[28:31]
    v_mfma_f32_16x16x32_bf16 v[56:59], v[120:123], v[112:115], v[56:59]
    v_mfma_f32_16x16x32_bf16 v[84:87], v[112:115], v[124:127], v[84:87]
    s_waitcnt lgkmcnt(0)
    v_mfma_f32_16x16x32_bf16 v[4:7], v[156:159], v[128:131], v[4:7]
    s_barrier
    v_mfma_f32_16x16x32_bf16 v[32:35], v[160:163], v[128:131], v[32:35]
    ds_read_b64_tr_b16 v[116:117], v250 offset:0
    v_mfma_f32_16x16x32_bf16 v[60:63], v[128:131], v[164:167], v[60:63]
    ds_read_b64_tr_b16 v[118:119], v250 offset:2048
    v_mfma_f32_16x16x32_bf16 v[8:11], v[156:159], v[132:135], v[8:11]
    ds_read_b64_tr_b16 v[120:121], v250 offset:4096
    v_mfma_f32_16x16x32_bf16 v[36:39], v[160:163], v[132:135], v[36:39]
    ds_read_b64_tr_b16 v[122:123], v250 offset:6144
    v_mfma_f32_16x16x32_bf16 v[64:67], v[132:135], v[164:167], v[64:67]
    ds_read_b64_tr_b16 v[124:125], v250 offset:8192
    v_mfma_f32_16x16x32_bf16 v[12:15], v[156:159], v[136:139], v[12:15]
    ds_read_b64_tr_b16 v[126:127], v250 offset:10240
    v_mfma_f32_16x16x32_bf16 v[40:43], v[160:163], v[136:139], v[40:43]
    ds_read_b128 v[88:91], v248 offset:0
    v_mfma_f32_16x16x32_bf16 v[68:71], v[136:139], v[164:167], v[68:71]
    ds_read_b128 v[92:95], v248 offset:2048
    v_mfma_f32_16x16x32_bf16 v[16:19], v[156:159], v[140:143], v[16:19]
    ds_read_b128 v[96:99], v248 offset:4096
    v_mfma_f32_16x16x32_bf16 v[44:47], v[160:163], v[140:143], v[44:47]
    ds_read_b128 v[100:103], v248 offset:6144
    v_mfma_f32_16x16x32_bf16 v[72:75], v[140:143], v[164:167], v[72:75]
    ds_read_b128 v[104:107], v248 offset:8192
    v_mfma_f32_16x16x32_bf16 v[20:23], v[156:159], v[144:147], v[20:23]
    ds_read_b128 v[108:111], v248 offset:10240
    v_mfma_f32_16x16x32_bf16 v[48:51], v[160:163], v[144:147], v[48:51]
    ds_read_b128 v[112:115], v248 offset:12288
    v_mfma_f32_16x16x32_bf16 v[76:79], v[144:147], v[164:167], v[76:79]
    v_mfma_f32_16x16x32_bf16 v[24:27], v[156:159], v[148:151], v[24:27]
    v_mfma_f32_16x16x32_bf16 v[52:55], v[160:163], v[148:151], v[52:55]
    v_mfma_f32_16x16x32_bf16 v[80:83], v[148:151], v[164:167], v[80:83]
    v_mfma_f32_16x16x32_bf16 v[28:31], v[156:159], v[152:155], v[28:31]
    v_mfma_f32_16x16x32_bf16 v[56:59], v[160:163], v[152:155], v[56:59]
    v_mfma_f32_16x16x32_bf16 v[84:87], v[152:155], v[164:167], v[84:87]
    s_waitcnt lgkmcnt(0)
    v_mfma_f32_16x16x32_bf16 v[4:7], v[116:119], v[88:91], v[4:7]
    ds_read_b64_tr_b16 v[156:157], v250 offset:12288
    v_mfma_f32_16x16x32_bf16 v[32:35], v[120:123], v[88:91], v[32:35]
    ds_read_b64_tr_b16 v[158:159], v250 offset:14336
    v_mfma_f32_16x16x32_bf16 v[60:63], v[88:91], v[124:127], v[60:63]
    ds_read_b64_tr_b16 v[160:161], v250 offset:16384
    v_mfma_f32_16x16x32_bf16 v[8:11], v[116:119], v[92:95], v[8:11]
    ds_read_b64_tr_b16 v[162:163], v250 offset:18432
    v_mfma_f32_16x16x32_bf16 v[36:39], v[120:123], v[92:95], v[36:39]
    ds_read_b64_tr_b16 v[164:165], v250 offset:20480
    v_mfma_f32_16x16x32_bf16 v[64:67], v[92:95], v[124:127], v[64:67]
    ds_read_b64_tr_b16 v[166:167], v250 offset:22528
    v_mfma_f32_16x16x32_bf16 v[12:15], v[116:119], v[96:99], v[12:15]
    ds_read_b128 v[128:131], v249 offset:0
    v_mfma_f32_16x16x32_bf16 v[40:43], v[120:123], v[96:99], v[40:43]
    ds_read_b128 v[132:135], v249 offset:2048
    v_mfma_f32_16x16x32_bf16 v[68:71], v[96:99], v[124:127], v[68:71]
    ds_read_b128 v[136:139], v249 offset:4096
    v_mfma_f32_16x16x32_bf16 v[16:19], v[116:119], v[100:103], v[16:19]
    ds_read_b128 v[140:143], v249 offset:6144
    v_mfma_f32_16x16x32_bf16 v[44:47], v[120:123], v[100:103], v[44:47]
    ds_read_b128 v[144:147], v249 offset:8192
    v_mfma_f32_16x16x32_bf16 v[72:75], v[100:103], v[124:127], v[72:75]
    ds_read_b128 v[148:151], v249 offset:10240
    v_mfma_f32_16x16x32_bf16 v[20:23], v[116:119], v[104:107], v[20:23]
    ds_read_b128 v[152:155], v249 offset:12288
    v_mfma_f32_16x16x32_bf16 v[48:51], v[120:123], v[104:107], v[48:51]
    s_cmp_eq_u32 s58, 3
    s_cbranch_scc1 L_xres_3
L_xret_3:
    v_mfma_f32_16x16x32_bf16 v[76:79], v[104:107], v[124:127], v[76:79]
    v_add_u32 v248, 77824, v248
    v_mfma_f32_16x16x32_bf16 v[24:27], v[116:119], v[108:111], v[24:27]
    v_add_u32 v249, 77824, v249
    v_mfma_f32_16x16x32_bf16 v[52:55], v[120:123], v[108:111], v[52:55]
    v_add_u32 v250, 77824, v250
    v_mfma_f32_16x16x32_bf16 v[80:83], v[108:111], v[124:127], v[80:83]
    v_mfma_f32_16x16x32_bf16 v[28:31], v[116:119], v[112:115], v[28:31]
    v_mfma_f32_16x16x32_bf16 v[56:59], v[120:123], v[112:115], v[56:59]
    v_mfma_f32_16x16x32_bf16 v[84:87], v[112:115], v[124:127], v[84:87]
    s_waitcnt lgkmcnt(0)
    v_mfma_f32_16x16x32_bf16 v[4:7], v[156:159], v[128:131], v[4:7]
    s_barrier
    v_mfma_f32_16x16x32_bf16 v[32:35], v[160:163], v[128:131], v[32:35]
    ds_read_b64_tr_b16 v[116:117], v250 offset:0
    v_mfma_f32_16x16x32_bf16 v[60:63], v[128:131], v[164:167], v[60:63]
    ds_read_b64_tr_b16 v[118:119], v250 offset:2048
    v_mfma_f32_16x16x32_bf16 v[8:11], v[156:159], v[132:135], v[8:11]
    ds_read_b64_tr_b16 v[120:121], v250 offset:4096
    v_mfma_f32_16x16x32_bf16 v[36:39], v[160:163], v[132:135], v[36:39]
    ds_read_b64_tr_b16 v[122:123], v250 offset:6144
    v_mfma_f32_16x16x32_bf16 v[64:67], v[132:135], v[164:167], v[64:67]
    ds_read_b64_tr_b16 v[124:125], v250 offset:8192
    v_mfma_f32_16x16x32_bf16 v[12:15], v[156:159], v[136:139], v[12:15]
    ds_read_b64_tr_b16 v[126:127], v250 offset:10240
    v_mfma_f32_16x16x32_bf16 v[40:43], v[160:163], v[136:139], v[40:43]
    ds_read_b128 v[88:91], v248 offset:0
    v_mfma_f32_16x16x32_bf16 v[68:71], v[136:139], v[164:167], v[68:71]
    ds_read_b128 v[92:95], v248 offset:2048
    v_mfma_f32_16x16x32_bf16 v[16:19], v[156:159], v[140:143], v[16:19]
    ds_read_b128 v[96:99], v248 offset:4096
    v_mfma_f32_16x16x32_bf16 v[44:47], v[160:163], v[140:143], v[44:47]
    ds_read_b128 v[100:103], v248 offset:6144
    v_mfma_f32_16x16x32_bf16 v[72:75], v[140:143], v[164:167], v[72:75]
    ds_read_b128 v[104:107], v248 offset:8192
    v_mfma_f32_16x16x32_bf16 v[20:23], v[156:159], v[144:147], v[20:23]
    ds_read_b128 v[108:111], v248 offset:10240
    v_mfma_f32_16x16x32_bf16 v[48:51], v[160:163], v[144:147], v[48:51]
    ds_read_b128 v[112:115], v248 offset:12288
    v_mfma_f32_16x16x32_bf16 v[76:79], v[144:147], v[164:167], v[76:79]
    v_mfma_f32_16x16x32_bf16 v[24:27], v[156:159], v[148:151], v[24:27]
    v_mfma_f32_16x16x32_bf16 v[52:55], v[160:163], v[148:151], v[52:55]
    v_mfma_f32_16x16x32_bf16 v[80:83], v[148:151], v[164:167], v[80:83]
    v_mfma_f32_16x16x32_bf16 v[28:31], v[156:159], v[152:155], v[28:31]
    v_mfma_f32_16x16x32_bf16 v[56:59], v[160:163], v[152:155], v[56:59]
    v_mfma_f32_16x16x32_bf16 v[84:87], v[152:155], v[164:167], v[84:87]
    s_waitcnt lgkmcnt(0)
    v_mfma_f32_16x16x32_bf16 v[4:7], v[116:119], v[88:91], v[4:7]
    ds_read_b64_tr_b16 v[156:157], v250 offset:12288
    v_mfma_f32_16x16x32_bf16 v[32:35], v[120:123], v[88:91], v[32:35]
    ds_read_b64_tr_b16 v[158:159], v250 offset:14336
    v_mfma_f32_16x16x32_bf16 v[60:63], v[88:91], v[124:127], v[60:63]
    ds_read_b64_tr_b16 v[160:161], v250 offset:16384
    v_mfma_f32_16x16x32_bf16 v[8:11], v[116:119], v[92:95], v[8:11]
    ds_read_b64_tr_b16 v[162:163], v250 offset:18432
    v_mfma_f32_16x16x32_bf16 v[36:39], v[120:123], v[92:95], v[36:39]
    ds_read_b64_tr_b16 v[164:165], v250 offset:20480
    v_mfma_f32_16x16x32_bf16 v[64:67], v[92:95], v[124:127], v[64:67]
    ds_read_b64_tr_b16 v[166:167], v250 offset:22528
    v_mfma_f32_16x16x32_bf16 v[12:15], v[116:119], v[96:99], v[12:15]
    ds_read_b128 v[128:131], v249 offset:0
    v_mfma_f32_16x16x32_bf16 v[40:43], v[120:123], v[96:99], v[40:43]
    ds_read_b128 v[132:135], v249 offset:2048
    v_mfma_f32_16x16x32_bf16 v[68:71], v[96:99], v[124:127], v[68:71]
    ds_read_b128 v[136:139], v249 offset:4096
    v_mfma_f32_16x16x32_bf16 v[16:19], v[116:119], v[100:103], v[16:19]
    ds_read_b128 v[140:143], v249 offset:6144
    v_mfma_f32_16x16x32_bf16 v[44:47], v[120:123], v[100:103], v[44:47]
    ds_read_b128 v[144:147], v249 offset:8192
    v_mfma_f32_16x16x32_bf16 v[72:75], v[100:103], v[124:127], v[72:75]
    ds_read_b128 v[148:151], v249 offset:10240
    v_mfma_f32_16x16x32_bf16 v[20:23], v[116:119], v[104:107], v[20:23]
    ds_read_b128 v[152:155], v249 offset:12288
    v_mfma_f32_16x16x32_bf16 v[48:51], v[120:123], v[104:107], v[48:51]
    s_cmp_eq_u32 s58, 4
    s_cbranch_scc1 L_xres_4
L_xret_4:
    v_mfma_f32_16x16x32_bf16 v[76:79], v[104:107], v[124:127], v[76:79]
    v_add_u32 v248, 4294928384, v248
    v_mfma_f32_16x16x32_bf16 v[24:27], v[116:119], v[108:111], v[24:27]
    v_add_u32 v249, 4294928384, v249
    v_mfma_f32_16x16x32_bf16 v[52:55], v[120:123], v[108:111], v[52:55]
    v_add_u32 v250, 4294928384, v250
    v_mfma_f32_16x16x32_bf16 v[80:83], v[108:111], v[124:127], v[80:83]
    s_waitcnt vmcnt(0)
    v_mfma_f32_16x16x32_bf16 v[28:31], v[116:119], v[112:115], v[28:31]
L_pg1:
    s_cbranch_execz L_hopret
    v_mfma_f32_16x16x32_bf16 v[56:59], v[120:123], v[112:115], v[56:59]
    v_mfma_f32_16x16x32_bf16 v[84:87], v[112:115], v[124:127], v[84:87]
    s_waitcnt lgkmcnt(0)
    v_mfma_f32_16x16x32_bf16 v[4:7], v[156:159], v[128:131], v[4:7]
    s_barrier
    v_mfma_f32_16x16x32_bf16 v[32:35], v[160:163], v[128:131], v[32:35]
    ds_read_b64_tr_b16 v[116:117], v250 offset:0
    v_mfma_f32_16x16x32_bf16 v[60:63], v[128:131], v[164:167], v[60:63]
    ds_read_b64_tr_b16 v[118:119], v250 offset:2048
    v_mfma_f32_16x16x32_bf16 v[8:11], v[156:159], v[132:135], v[8:11]
    ds_read_b64_tr_b16 v[120:121], v250 offset:4096
    v_mfma_f32_16x16x32_bf16 v[36:39], v[160:163], v[132:135], v[36:39]
    ds_read_b64_tr_b16 v[122:123], v250 offset:6144
    v_mfma_f32_16x16x32_bf16 v[64:67], v[132:135], v[164:167], v[64:67]
    ds_read_b64_tr_b16 v[124:125], v250 offset:8192
    v_mfma_f32_16x16x32_bf16 v[12:15], v[156:159], v[136:139], v[12:15]
    ds_read_b64_tr_b16 v[126:127], v250 offset:10240
    v_mfma_f32_16x16x32_bf16 v[40:43], v[160:163], v[136:139], v[40:43]
    ds_read_b128 v[88:91], v248 offset:0
    v_mfma_f32_16x16x32_bf16 v[68:71], v[136:139], v[164:167], v[68:71]
    ds_read_b128 v[92:95], v248 offset:2048
    v_mfma_f32_16x16x32_bf16 v[16:19], v[156:159], v[140:143], v[16:19]
    ds_read_b128 v[96:99], v248 offset:4096
    v_mfma_f32_16x16x32_bf16 v[44:47], v[160:163], v[140:143], v[44:47]
    ds_read_b128 v[100:103], v248 offset:6144
    v_mfma_f32_16x16x32_bf16 v[72:75], v[140:143], v[164:167], v[72:75]
    ds_read_b128 v[104:107], v248 offset:8192
    v_mfma_f32_16x16x32_bf16 v[20:23], v[156:159], v[144:147], v[20:23]
    ds_read_b128 v[108:111], v248 offset:10240
    v_mfma_f32_16x16x32_bf16 v[48:51], v[160:163], v[144:147], v[48:51]
    ds_read_b128 v[112:115], v248 offset:12288
    v_mfma_f32_16x16x32_bf16 v[76:79], v[144:147], v[164:167], v[76:79]
    v_mfma_f32_16x16x32_bf16 v[24:27], v[156:159], v[148:151], v[24:27]
    v_mfma_f32_16x16x32_bf16 v[52:55], v[160:163], v[148:151], v[52:55]
    v_mfma_f32_16x16x32_bf16 v[80:83], v[148:151], v[164:167], v[80:83]
    v_mfma_f32_16x16x32_bf16 v[28:31], v[156:159], v[152:155], v[28:31]
    v_mfma_f32_16x16x32_bf16 v[56:59], v[160:163], v[152:155], v[56:59]
    v_mfma_f32_16x16x32_bf16 v[84:87], v[152:155], v[164:167], v[84:87]
    s_waitcnt lgkmcnt(0)
    v_mfma_f32_16x16x32_bf16 v[4:7], v[116:119], v[88:91], v[4:7]
    ds_read_b64_tr_b16 v[156:157], v250 offset:12288
    v_mfma_f32_16x16x32_bf16 v[32:35], v[120:123], v[88:91], v[32:35]
    ds_read_b64_tr_b16 v[158:159], v250 offset:14336
    v_mfma_f32_16x16x32_bf16 v[60:63], v[88:91], v[124:127], v[60:63]
    ds_read_b64_tr_b16 v[160:161], v250 offset:16384
    v_mfma_f32_16x16x32_bf16 v[8:11], v[116:119], v[92:95], v[8:11]
    ds_read_b64_tr_b16 v[162:163], v250 offset:18432
    v_mfma_f32_16x16x32_bf16 v[36:39], v[120:123], v[92:95], v[36:39]
    ds_read_b64_tr_b16 v[164:165], v250 offset:20480
    v_mfma_f32_16x16x32_bf16 v[64:67], v[92:95], v[124:127], v[64:67]
    ds_read_b64_tr_b16 v[166:167], v250 offset:22528
    v_mfma_f32_16x16x32_bf16 v[12:15], v[116:119], v[96:99], v[12:15]
    ds_read_b128 v[128:131], v249 offset:0
    v_mfma_f32_16x16x32_bf16 v[40:43], v[120:123], v[96:99], v[40:43]
    ds_read_b128 v[132:135], v249 offset:2048
    v_mfma_f32_16x16x32_bf16 v[68:71], v[96:99], v[124:127], v[68:71]
    ds_read_b128 v[136:139], v249 offset:4096
    v_mfma_f32_16x16x32_bf16 v[16:19], v[116:119], v[100:103], v[16:19]
    ds_read_b128 v[140:143], v249 offset:6144
    v_mfma_f32_16x16x32_bf16 v[44:47], v[120:123], v[100:103], v[44:47]
    ds_read_b128 v[144:147], v249 offset:8192
    v_mfma_f32_16x16x32_bf16 v[72:75], v[100:103], v[124:127], v[72:75]
    ds_read_b128 v[148:151], v249 offset:10240
    v_mfma_f32_16x16x32_bf16 v[20:23], v[116:119], v[104:107], v[20:23]
    ds_read_b128 v[152:155], v249 offset:12288
    v_mfma_f32_16x16x32_bf16 v[48:51], v[120:123], v[104:107], v[48:51]
    s_cmp_eq_u32 s58, 5
    s_cbranch_scc1 L_xres_5
L_xret_5:
    v_mfma_f32_16x16x32_bf16 v[76:79], v[104:107], v[124:127], v[76:79]
    v_add_u32 v248, 4294928384, v248
    v_mfma_f32_16x16x32_bf16 v[24:27], v[116:119], v[108:111], v[24:27]
    v_add_u32 v249, 4294928384, v249
    v_mfma_f32_16x16x32_bf16 v[52:55], v[120:123], v[108:111], v[52:55]
    v_add_u32 v250, 4294928384, v250
    v_mfma_f32_16x16x32_bf16 v[80:83], v[108:111], v[124:127], v[80:83]
    v_mfma_f32_16x16x32_bf16 v[28:31], v[116:119], v[112:115], v[28:31]
    v_mfma_f32_16x16x32_bf16 v[56:59], v[120:123], v[112:115], v[56:59]
    v_mfma_f32_16x16x32_bf16 v[84:87], v[112:115], v[124:127], v[84:87]
    s_waitcnt lgkmcnt(0)
    v_mfma_f32_16x16x32_bf16 v[4:7], v[156:159], v[128:131], v[4:7]
    s_barrier
    v_mfma_f32_16x16x32_bf16 v[32:35], v[160:163], v[128:131], v[32:35]
    ds_read_b64_tr_b16 v[116:117], v250 offset:0
    v_mfma_f32_16x16x32_bf16 v[60:63], v[128:131], v[164:167], v[60:63]
    ds_read_b64_tr_b16 v[118:119], v250 offset:2048
    v_mfma_f32_16x16x32_bf16 v[8:11], v[156:159], v[132:135], v[8:11]
    ds_read_b64_tr_b16 v[120:121], v250 offset:4096
    v_mfma_f32_16x16x32_bf16 v[36:39], v[160:163], v[132:135], v[36:39]
    ds_read_b64_tr_b16 v[122:123], v250 offset:6144
    v_mfma_f32_16x16x32_bf16 v[64:67], v[132:135], v[164:167], v[64:67]
    ds_read_b64_tr_b16 v[124:125], v250 offset:8192
    v_mfma_f32_16x16x32_bf16 v[12:15], v[156:159], v[136:139], v[12:15]
    ds_read_b64_tr_b16 v[126:127], v250 offset:10240
    v_mfma_f32_16x16x32_bf16 v[40:43], v[160:163], v[136:139], v[40:43]
    ds_read_b128 v[88:91], v248 offset:0
    v_mfma_f32_16x16x32_bf16 v[68:71], v[136:139], v[164:167], v[68:71]
    ds_read_b128 v[92:95], v248 offset:2048
    v_mfma_f32_16x16x32_bf16 v[16:19], v[156:159], v[140:143], v[16:19]
    ds_read_b128 v[96:99], v248 offset:4096
    v_mfma_f32_16x16x32_bf16 v[44:47], v[160:163], v[140:143], v[44:47]
    ds_read_b128 v[100:103], v248 offset:6144
    v_mfma_f32_16x16x32_bf16 v[72:75], v[140:143], v[164:167], v[72:75]
    ds_read_b128 v[104:107], v248 offset:8192
    v_mfma_f32_16x16x32_bf16 v[20:23], v[156:159], v[144:147], v[20:23]
    ds_read_b128 v[108:111], v248 offset:10240
    v_mfma_f32_16x16x32_bf16 v[48:51], v[160:163], v[144:147], v[48:51]
    ds_read_b128 v[112:115], v248 offset:12288
    v_mfma_f32_16x16x32_bf16 v[76:79], v[144:147], v[164:167], v[76:79]
    v_mfma_f32_16x16x32_bf16 v[24:27], v[156:159], v[148:151], v[24:27]
    v_mfma_f32_16x16x32_bf16 v[52:55], v[160:163], v[148:151], v[52:55]
    v_mfma_f32_16x16x32_bf16 v[80:83], v[148:151], v[164:167], v[80:83]
    v_mfma_f32_16x16x32_bf16 v[28:31], v[156:159], v[152:155], v[28:31]
    v_mfma_f32_16x16x32_bf16 v[56:59], v[160:163], v[152:155], v[56:59]
    v_mfma_f32_16x16x32_bf16 v[84:87], v[152:155], v[164:167], v[84:87]
    s_waitcnt lgkmcnt(0)
    v_mfma_f32_16x16x32_bf16 v[4:7], v[116:119], v[88:91], v[4:7]
    ds_read_b64_tr_b16 v[156:157], v250 offset:12288
    v_mfma_f32_16x16x32_bf16 v[32:35], v[120:123], v[88:91], v[32:35]
    ds_read_b64_tr_b16 v[158:159], v250 offset:14336
    v_mfma_f32_16x16x32_bf16 v[60:63], v[88:91], v[124:127], v[60:63]
    ds_read_b64_tr_b16 v[160:161], v250 offset:16384
    v_mfma_f32_16x16x32_bf16 v[8:11], v[116:119], v[92:95], v[8:11]
    ds_read_b64_tr_b16 v[162:163], v250 offset:18432
    v_mfma_f32_16x16x32_bf16 v[36:39], v[120:123], v[92:95], v[36:39]
    ds_read_b64_tr_b16 v[164:165], v250 offset:20480
    v_mfma_f32_16x16x32_bf16 v[64:67], v[92:95], v[124:127], v[64:67]
    ds_read_b64_tr_b16 v[166:167], v250 offset:22528
    v_mfma_f32_16x16x32_bf16 v[12:15], v[116:119], v[96:99], v[12:15]
    ds_read_b128 v[128:131], v249 offset:0
    v_mfma_f32_16x16x32_bf16 v[40:43], v[120:123], v[96:99], v[40:43]
    ds_read_b128 v[132:135], v249 offset:2048
    v_mfma_f32_16x16x32_bf16 v[68:71], v[96:99], v[124:127], v[68:71]
    ds_read_b128 v[136:139], v249 offset:4096
    v_mfma_f32_16x16x32_bf16 v[16:19], v[116:119], v[100:103], v[16:19]
    ds_read_b128 v[140:143], v249 offset:6144
    v_mfma_f32_16x16x32_bf16 v[44:47], v[120:123], v[100:103], v[44:47]
    ds_read_b128 v[144:147], v249 offset:8192
    v_mfma_f32_16x16x32_bf16 v[72:75], v[100:103], v[124:127], v[72:75]
    ds_read_b128 v[148:151], v249 offset:10240
    v_mfma_f32_16x16x32_bf16 v[20:23], v[116:119], v[104:107], v[20:23]
    ds_read_b128 v[152:155], v249 offset:12288
    v_mfma_f32_16x16x32_bf16 v[48:51], v[120:123], v[104:107], v[48:51]
    s_cmp_eq_u32 s58, 6
    s_cbranch_scc1 L_xres_6
L_xret_6:
    v_mfma_f32_16x16x32_bf16 v[76:79], v[104:107], v[124:127], v[76:79]
    v_add_u32 v248, 77824, v248
    v_mfma_f32_16x16x32_bf16 v[24:27], v[116:119], v[108:111], v[24:27]
    v_add_u32 v249, 77824, v249
    v_mfma_f32_16x16x32_bf16 v[52:55], v[120:123], v[108:111], v[52:55]
    v_add_u32 v250, 77824, v250
    v_mfma_f32_16x16x32_bf16 v[80:83], v[108:111], v[124:127], v[80:83]
    v_mfma_f32_16x16x32_bf16 v[28:31], v[116:119], v[112:115], v[28:31]
    v_mfma_f32_16x16x32_bf16 v[56:59], v[120:123], v[112:115], v[56:59]
    v_mfma_f32_16x16x32_bf16 v[84:87], v[112:115], v[124:127], v[84:87]
    s_waitcnt lgkmcnt(0)
    v_mfma_f32_16x16x32_bf16 v[4:7], v[156:159], v[128:131], v[4:7]
    s_barrier
    v_mfma_f32_16x16x32_bf16 v[32:35], v[160:163], v[128:131], v[32:35]
    ds_read_b64_tr_b16 v[116:117], v250 offset:0
    v_mfma_f32_16x16x32_bf16 v[60:63], v[128:131], v[164:167], v[60:63]
    ds_read_b64_tr_b16 v[118:119], v250 offset:2048
    v_mfma_f32_16x16x32_bf16 v[8:11], v[156:159], v[132:135], v[8:11]
    ds_read_b64_tr_b16 v[120:121], v250 offset:4096
    v_mfma_f32_16x16x32_bf16 v[36:39], v[160:163], v[132:135], v[36:39]
    ds_read_b64_tr_b16 v[122:123], v250 offset:6144
    v_mfma_f32_16x16x32_bf16 v[64:67], v[132:135], v[164:167], v[64:67]
    ds_read_b64_tr_b16 v[124:125], v250 offset:8192
    v_mfma_f32_16x16x32_bf16 v[12:15], v[156:159], v[136:139], v[12:15]
    ds_read_b64_tr_b16 v[126:127], v250 offset:10240
    v_mfma_f32_16x16x32_bf16 v[40:43], v[160:163], v[136:139], v[40:43]
    ds_read_b128 v[88:91], v248 offset:0
    v_mfma_f32_16x16x32_bf16 v[68:71], v[136:139], v[164:167], v[68:71]
    ds_read_b128 v[92:95], v248 offset:2048
    v_mfma_f32_16x16x32_bf16 v[16:19], v[156:159], v[140:143], v[16:19]
    ds_read_b128 v[96:99], v248 offset:4096
    v_mfma_f32_16x16x32_bf16 v[44:47], v[160:163], v[140:143], v[44:47]
    ds_read_b128 v[100:103], v248 offset:6144
    v_mfma_f32_16x16x32_bf16 v[72:75], v[140:143], v[164:167], v[72:75]
    ds_read_b128 v[104:107], v248 offset:8192
    v_mfma_f32_16x16x32_bf16 v[20:23], v[156:159], v[144:147], v[20:23]
    ds_read_b128 v[108:111], v248 offset:10240
    v_mfma_f32_16x16x32_bf16 v[48:51], v[160:163], v[144:147], v[48:51]
    ds_read_b128 v[112:115], v248 offset:12288
    v_mfma_f32_16x16x32_bf16 v[76:79], v[144:147], v[164:167], v[76:79]
    v_mfma_f32_16x16x32_bf16 v[24:27], v[156:159], v[148:151], v[24:27]
    v_mfma_f32_16x16x32_bf16 v[52:55], v[160:163], v[148:151], v[52:55]
    v_mfma_f32_16x16x32_bf16 v[80:83], v[148:151], v[164:167], v[80:83]
    v_mfma_f32_16x16x32_bf16 v[28:31], v[156:159], v[152:155], v[28:31]
    v_mfma_f32_16x16x32_bf16 v[56:59], v[160:163], v[152:155], v[56:59]
    v_mfma_f32_16x16x32_bf16 v[84:87], v[152:155], v[164:167], v[84:87]
    s_waitcnt lgkmcnt(0)
    v_mfma_f32_16x16x32_bf16 v[4:7], v[116:119], v[88:91], v[4:7]
    ds_read_b64_tr_b16 v[156:157], v250 offset:12288
    v_mfma_f32_16x16x32_bf16 v[32:35], v[120:123], v[88:91], v[32:35]
    ds_read_b64_tr_b16 v[158:159], v250 offset:14336
    v_mfma_f32_16x16x32_bf16 v[60:63], v[88:91], v[124:127], v[60:63]
    ds_read_b64_tr_b16 v[160:161], v250 offset:16384
    v_mfma_f32_16x16x32_bf16 v[8:11], v[116:119], v[92:95], v[8:11]
    ds_read_b64_tr_b16 v[162:163], v250 offset:18432
    v_mfma_f32_16x16x32_bf16 v[36:39], v[120:123], v[92:95], v[36:39]
    ds_read_b64_tr_b16 v[164:165], v250 offset:20480
    v_mfma_f32_16x16x32_bf16 v[64:67], v[92:95], v[124:127], v[64:67]
    ds_read_b64_tr_b16 v[166:167], v250 offset:22528
    v_mfma_f32_16x16x32_bf16 v[12:15], v[116:119], v[96:99], v[12:15]
    ds_read_b128 v[128:131], v249 offset:0
    v_mfma_f32_16x16x32_bf16 v[40:43], v[120:123], v[96:99], v[40:43]
    ds_read_b128 v[132:135], v249 offset:2048
    v_mfma_f32_16x16x32_bf16 v[68:71], v[96:99], v[124:127], v[68:71]
    ds_read_b128 v[136:139], v249 offset:4096
    v_mfma_f32_16x16x32_bf16 v[16:19], v[116:119], v[100:103], v[16:19]
    ds_read_b128 v[140:143], v249 offset:6144
    v_mfma_f32_16x16x32_bf16 v[44:47], v[120:123], v[100:103], v[44:47]
    ds_read_b128 v[144:147], v249 offset:8192
    v_mfma_f32_16x16x32_bf16 v[72:75], v[100:103], v[124:127], v[72:75]
    ds_read_b128 v[148:151], v249 offset:10240
    v_mfma_f32_16x16x32_bf16 v[20:23], v[116:119], v[104:107], v[20:23]
    ds_read_b128 v[152:155], v249 offset:12288
    v_mfma_f32_16x16x32_bf16 v[48:51], v[120:123], v[104:107], v[48:51]
    s_cmp_eq_u32 s58, 7
    s_cbranch_scc1 L_xres_7
L_xret_7:
    v_mfma_f32_16x16x32_bf16 v[76:79], v[104:107], v[124:127], v[76:79]
    v_add_u32 v248, 4294928384, v248
    v_mfma_f32_16x16x32_bf16 v[24:27], v[116:119], v[108:111], v[24:27]
    v_add_u32 v249, 4294928384, v249
    v_mfma_f32_16x16x32_bf16 v[52:55], v[120:123], v[108:111], v[52:55]
    v_add_u32 v250, 4294928384, v250
    v_mfma_f32_16x16x32_bf16 v[80:83], v[108:111], v[124:127], v[80:83]
    v_mfma_f32_16x16x32_bf16 v[28:31], v[116:119], v[112:115], v[28:31]
    v_mfma_f32_16x16x32_bf16 v[56:59], v[120:123], v[112:115], v[56:59]
    v_mfma_f32_16x16x32_bf16 v[84:87], v[112:115], v[124:127], v[84:87]
    s_waitcnt lgkmcnt(0)
    v_mfma_f32_16x16x32_bf16 v[4:7], v[156:159], v[128:131], v[4:7]
    s_barrier
    v_mfma_f32_16x16x32_bf16 v[32:35], v[160:163], v[128:131], v[32:35]
    ds_read_b64_tr_b16 v[116:117], v250 offset:0
    v_mfma_f32_16x16x32_bf16 v[60:63], v[128:131], v[164:167], v[60:63]
    ds_read_b64_tr_b16 v[118:119], v250 offset:2048
    v_mfma_f32_16x16x32_bf16 v[8:11], v[156:159], v[132:135], v[8:11]
    ds_read_b64_tr_b16 v[120:121], v250 offset:4096
    v_mfma_f32_16x16x32_bf16 v[36:39], v[160:163], v[132:135], v[36:39]
    ds_read_b64_tr_b16 v[122:123], v250 offset:6144
    v_mfma_f32_16x16x32_bf16 v[64:67], v[132:135], v[164:167], v[64:67]
    ds_read_b64_tr_b16 v[124:125], v250 offset:8192
    v_mfma_f32_16x16x32_bf16 v[12:15], v[156:159], v[136:139], v[12:15]
    ds_read_b64_tr_b16 v[126:127], v250 offset:10240
    v_mfma_f32_16x16x32_bf16 v[40:43], v[160:163], v[136:139], v[40:43]
    ds_read_b128 v[88:91], v248 offset:0
    v_mfma_f32_16x16x32_bf16 v[68:71], v[136:139], v[164:167], v[68:71]
    ds_read_b128 v[92:95], v248 offset:2048
    v_mfma_f32_16x16x32_bf16 v[16:19], v[156:159], v[140:143], v[16:19]
    ds_read_b128 v[96:99], v248 offset:4096
    v_mfma_f32_16x16x32_bf16 v[44:47], v[160:163], v[140:143], v[44:47]
    ds_read_b128 v[100:103], v248 offset:6144
    v_mfma_f32_16x16x32_bf16 v[72:75], v[140:143], v[164:167], v[72:75]
    ds_read_b128 v[104:107], v248 offset:8192
    v_mfma_f32_16x16x32_bf16 v[20:23], v[156:159], v[144:147], v[20:23]
    ds_read_b128 v[108:111], v248 offset:10240
    v_mfma_f32_16x16x32_bf16 v[48:51], v[160:163], v[144:147], v[48:51]
    ds_read_b128 v[112:115], v248 offset:12288
    v_mfma_f32_16x16x32_bf16 v[76:79], v[144:147], v[164:167], v[76:79]
    s_lshl_b32 s53, s59, 8
    s_add_u32 s53, s53, 5990144
    s_add_u32 s21, s53, 128
    v_mfma_f32_16x16x32_bf16 v[24:27], v[156:159], v[148:151], v[24:27]
    v_mfma_f32_16x16x32_bf16 v[52:55], v[160:163], v[148:151], v[52:55]
    v_mfma_f32_16x16x32_bf16 v[80:83], v[148:151], v[164:167], v[80:83]
    v_mfma_f32_16x16x32_bf16 v[28:31], v[156:159], v[152:155], v[28:31]
    v_mfma_f32_16x16x32_bf16 v[56:59], v[160:163], v[152:155], v[56:59]
    v_mfma_f32_16x16x32_bf16 v[84:87], v[152:155], v[164:167], v[84:87]
    s_waitcnt lgkmcnt(0)
    v_mfma_f32_16x16x32_bf16 v[4:7], v[116:119], v[88:91], v[4:7]
    ds_read_b64_tr_b16 v[156:157], v250 offset:12288
    s_load_dword s0, s[40:41], s53
    v_mfma_f32_16x16x32_bf16 v[32:35], v[120:123], v[88:91], v[32:35]
    ds_read_b64_tr_b16 v[158:159], v250 offset:14336
    s_load_dword s1, s[40:41], s21
    v_mfma_f32_16x16x32_bf16 v[60:63], v[88:91], v[124:127], v[60:63]
    ds_read_b64_tr_b16 v[160:161], v250 offset:16384
    v_mfma_f32_16x16x32_bf16 v[8:11], v[116:119], v[92:95], v[8:11]
    ds_read_b64_tr_b16 v[162:163], v250 offset:18432
    v_mfma_f32_16x16x32_bf16 v[36:39], v[120:123], v[92:95], v[36:39]
    ds_read_b64_tr_b16 v[164:165], v250 offset:20480
    v_mfma_f32_16x16x32_bf16 v[64:67], v[92:95], v[124:127], v[64:67]
    ds_read_b64_tr_b16 v[166:167], v250 offset:22528
    v_mfma_f32_16x16x32_bf16 v[12:15], v[116:119], v[96:99], v[12:15]
    ds_read_b128 v[128:131], v249 offset:0
    v_mfma_f32_16x16x32_bf16 v[40:43], v[120:123], v[96:99], v[40:43]
    ds_read_b128 v[132:135], v249 offset:2048
    v_mfma_f32_16x16x32_bf16 v[68:71], v[96:99], v[124:127], v[68:71]
    ds_read_b128 v[136:139], v249 offset:4096
    v_mfma_f32_16x16x32_bf16 v[16:19], v[116:119], v[100:103], v[16:19]
    ds_read_b128 v[140:143], v249 offset:6144
    v_mfma_f32_16x16x32_bf16 v[44:47], v[120:123], v[100:103], v[44:47]
    ds_read_b128 v[144:147], v249 offset:8192
    v_mfma_f32_16x16x32_bf16 v[72:75], v[100:103], v[124:127], v[72:75]
    ds_read_b128 v[148:151], v249 offset:10240
    v_mfma_f32_16x16x32_bf16 v[20:23], v[116:119], v[104:107], v[20:23]
    ds_read_b128 v[152:155], v249 offset:12288
    v_mfma_f32_16x16x32_bf16 v[48:51], v[120:123], v[104:107], v[48:51]
    s_cmp_eq_u32 s58, 8
    s_cbranch_scc1 L_xres_8
L_xret_8:
    v_mfma_f32_16x16x32_bf16 v[76:79], v[104:107], v[124:127], v[76:79]
    v_add_u32 v248, 4294928384, v248
    v_mfma_f32_16x16x32_bf16 v[24:27], v[116:119], v[108:111], v[24:27]
    v_add_u32 v249, 4294928384, v249
    v_mfma_f32_16x16x32_bf16 v[52:55], v[120:123], v[108:111], v[52:55]
    v_add_u32 v250, 4294928384, v250
    v_mfma_f32_16x16x32_bf16 v[80:83], v[108:111], v[124:127], v[80:83]
    v_mfma_f32_16x16x32_bf16 v[28:31], v[116:119], v[112:115], v[28:31]
    v_mfma_f32_16x16x32_bf16 v[56:59], v[120:123], v[112:115], v[56:59]
    v_mfma_f32_16x16x32_bf16 v[84:87], v[112:115], v[124:127], v[84:87]
    s_waitcnt lgkmcnt(0)
    v_mfma_f32_16x16x32_bf16 v[4:7], v[156:159], v[128:131], v[4:7]
    s_barrier
    v_mfma_f32_16x16x32_bf16 v[32:35], v[160:163], v[128:131], v[32:35]
    ds_read_b64_tr_b16 v[116:117], v250 offset:0
    v_mfma_f32_16x16x32_bf16 v[60:63], v[128:131], v[164:167], v[60:63]
    ds_read_b64_tr_b16 v[118:119], v250 offset:2048
    v_mfma_f32_16x16x32_bf16 v[8:11], v[156:159], v[132:135], v[8:11]
    ds_read_b64_tr_b16 v[120:121], v250 offset:4096
    v_mfma_f32_16x16x32_bf16 v[36:39], v[160:163], v[132:135], v[36:39]
    ds_read_b64_tr_b16 v[122:123], v250 offset:6144
    v_mfma_f32_16x16x32_bf16 v[64:67], v[132:135], v[164:167], v[64:67]
    ds_read_b64_tr_b16 v[124:125], v250 offset:8192
    v_mfma_f32_16x16x32_bf16 v[12:15], v[156:159], v[136:139], v[12:15]
    ds_read_b64_tr_b16 v[126:127], v250 offset:10240
    v_mfma_f32_16x16x32_bf16 v[40:43], v[160:163], v[136:139], v[40:43]
    ds_read_b128 v[88:91], v248 offset:0
    v_mfma_f32_16x16x32_bf16 v[68:71], v[136:139], v[164:167], v[68:71]
    ds_read_b128 v[92:95], v248 offset:2048
    v_mfma_f32_16x16x32_bf16 v[16:19], v[156:159], v[140:143], v[16:19]
    ds_read_b128 v[96:99], v248 offset:4096
    v_mfma_f32_16x16x32_bf16 v[44:47], v[160:163], v[140:143], v[44:47]
    ds_read_b128 v[100:103], v248 offset:6144
    v_mfma_f32_16x16x32_bf16 v[72:75], v[140:143], v[164:167], v[72:75]
    ds_read_b128 v[104:107], v248 offset:8192
    v_mfma_f32_16x16x32_bf16 v[20:23], v[156:159], v[144:147], v[20:23]
    ds_read_b128 v[108:111], v248 offset:10240
    v_mfma_f32_16x16x32_bf16 v[48:51], v[160:163], v[144:147], v[48:51]
    ds_read_b128 v[112:115], v248 offset:12288
    v_mfma_f32_16x16x32_bf16 v[76:79], v[144:147], v[164:167], v[76:79]
L_ac_c:
    s_add_u32 s63, s0, s1
    s_lshr_b32 s61, s63, 4
    s_and_b32 s61, s61, 0x0f0f0f0f
    v_mfma_f32_16x16x32_bf16 v[24:27], v[156:159], v[148:151], v[24:27]
    s_and_b32 s63, s63, 0x0f0f0f0f
    s_add_u32 s63, s63, s61
    s_mul_i32 s63, s63, 0x01010101
    v_mfma_f32_16x16x32_bf16 v[52:55], v[160:163], v[148:151], v[52:55]
    s_lshr_b32 s63, s63, 24
    s_cmp_ge_u32 s63, 10
    s_cbranch_scc0 L_ar_c
L_ao_c:
    v_mfma_f32_16x16x32_bf16 v[80:83], v[148:151], v[164:167], v[80:83]
    s_bitcmp1_b32 s2, 0
    s_cselect_b32 s63, s1, s0
    s_getreg_b32 s61, hwreg(HW_REG_XCC_ID, 0, 3)
    v_mfma_f32_16x16x32_bf16 v[28:31], v[156:159], v[152:155], v[28:31]
    s_lshl_b32 s61, s61, 2
    s_lshr_b32 s63, s63, s61
    v_mfma_f32_16x16x32_bf16 v[56:59], v[160:163], v[152:155], v[56:59]
    s_cmp_eq_u32 s63, 5
    s_cselect_b32 s53, 1, 0
    v_mfma_f32_16x16x32_bf16 v[84:87], v[152:155], v[164:167], v[84:87]
    s_waitcnt lgkmcnt(0)
    v_mfma_f32_16x16x32_bf16 v[32:35], v[120:123], v[88:91], v[32:35]
    ds_read_b64_tr_b16 v[160:161], v250 offset:16384
    ds_read_b64_tr_b16 v[162:163], v250 offset:18432
    v_mfma_f32_16x16x32_bf16 v[36:39], v[120:123], v[92:95], v[36:39]
    ds_read_b128 v[128:131], v249 offset:0
    ds_read_b128 v[132:135], v249 offset:2048
    v_mfma_f32_16x16x32_bf16 v[40:43], v[120:123], v[96:99], v[40:43]
    ds_read_b128 v[136:139], v249 offset:4096
    v_mfma_f32_16x16x32_bf16 v[44:47], v[120:123], v[100:103], v[44:47]
    ds_read_b128 v[140:143], v249 offset:6144
    ds_read_b128 v[144:147], v249 offset:8192
    v_mfma_f32_16x16x32_bf16 v[48:51], v[120:123], v[104:107], v[48:51]
    ds_read_b128 v[148:151], v249 offset:10240
    v_mfma_f32_16x16x32_bf16 v[52:55], v[120:123], v[108:111], v[52:55]
    ds_read_b128 v[152:155], v249 offset:12288
    ds_read_b64_tr_b16 v[156:157], v250 offset:12288
    v_mfma_f32_16x16x32_bf16 v[56:59], v[120:123], v[112:115], v[56:59]
    ds_read_b64_tr_b16 v[158:159], v250 offset:14336
    v_mfma_f32_16x16x32_bf16 v[4:7], v[116:119], v[88:91], v[4:7]
    ds_read_b64_tr_b16 v[164:165], v250 offset:20480
    ds_read_b64_tr_b16 v[166:167], v250 offset:22528
    v_mfma_f32_16x16x32_bf16 v[8:11], v[116:119], v[92:95], v[8:11]
    s_cmp_eq_u32 s58, 9
    s_cbranch_scc1 L_xres_9
L_xret_9:
    v_mfma_f32_16x16x32_bf16 v[12:15], v[116:119], v[96:99], v[12:15]
    s_waitcnt lgkmcnt(4)
    v_mfma_f32_16x16x32_bf16 v[32:35], v[160:163], v[128:131], v[32:35]
    s_mul_i32 s61, s52, 7168
    s_add_u32 s61, s61, 46080
    v_lshlrev_b32 v1, 3, v0
    v_mfma_f32_16x16x32_bf16 v[36:39], v[160:163], v[132:135], v[36:39]
    v_add_u32_e64 v2, s61, v1
    s_cmp_eq_u32 s53, 0
    s_cselect_b32 s70, 0, s81
    v_mfma_f32_16x16x32_bf16 v[40:43], v[160:163], v[136:139], v[40:43]
    s_cmp_eq_u32 s70, 0
    s_cselect_b64 vcc, 0, s[64:65]
    v_bfrev_b32_e64 v3, 1
    v_mfma_f32_16x16x32_bf16 v[44:47], v[160:163], v[140:143], v[44:47]
    v_cndmask_b32_e64 v1, v3, v1, vcc
    s_add_u32 s61, s80, 3584
    v_mfma_f32_16x16x32_bf16 v[48:51], v[160:163], v[144:147], v[48:51]
    v_mfma_f32_16x16x32_bf16 v[52:55], v[160:163], v[148:151], v[52:55]
    v_mfma_f32_16x16x32_bf16 v[56:59], v[160:163], v[152:155], v[56:59]
    s_waitcnt lgkmcnt(0)
    s_load_dword s75, s[44:45], 0
    s_cbranch_vccz L_nosend
    v_mfma_f32_16x16x32_bf16 v[16:19], v[116:119], v[100:103], v[16:19]
    v_cvt_pk_bf16_f32 v32, v32, v33
    v_mfma_f32_16x16x32_bf16 v[20:23], v[116:119], v[104:107], v[20:23]
    v_cvt_pk_bf16_f32 v33, v34, v35
    buffer_store_dwordx2 v[32:33], v1, s[40:43], s61 offen offset:0
    v_mfma_f32_16x16x32_bf16 v[24:27], v[116:119], v[108:111], v[24:27]
    v_cvt_pk_bf16_f32 v36, v36, v37
    v_cvt_pk_bf16_f32 v37, v38, v39
    v_mfma_f32_16x16x32_bf16 v[28:31], v[116:119], v[112:115], v[28:31]
    buffer_store_dwordx2 v[36:37], v1, s[40:43], s61 offen offset:512
    v_cvt_pk_bf16_f32 v40, v40, v41
    v_mfma_f32_16x16x32_bf16 v[4:7], v[156:159], v[128:131], v[4:7]
    v_cvt_pk_bf16_f32 v41, v42, v43
    buffer_store_dwordx2 v[40:41], v1, s[40:43], s61 offen offset:1024
    v_mfma_f32_16x16x32_bf16 v[8:11], v[156:159], v[132:135], v[8:11]
    v_cvt_pk_bf16_f32 v44, v44, v45
    v_cvt_pk_bf16_f32 v45, v46, v47
    v_mfma_f32_16x16x32_bf16 v[12:15], v[156:159], v[136:139], v[12:15]
    buffer_store_dwordx2 v[44:45], v1, s[40:43], s61 offen offset:1536
    v_cvt_pk_bf16_f32 v48, v48, v49
    v_mfma_f32_16x16x32_bf16 v[16:19], v[156:159], v[140:143], v[16:19]
    v_cvt_pk_bf16_f32 v49, v50, v51
    buffer_store_dwordx2 v[48:49], v1, s[40:43], s61 offen offset:2048
    v_mfma_f32_16x16x32_bf16 v[20:23], v[156:159], v[144:147], v[20:23]
    v_cvt_pk_bf16_f32 v52, v52, v53
    v_cvt_pk_bf16_f32 v53, v54, v55
    v_mfma_f32_16x16x32_bf16 v[24:27], v[156:159], v[148:151], v[24:27]
    buffer_store_dwordx2 v[52:53], v1, s[40:43], s61 offen offset:2560
    v_cvt_pk_bf16_f32 v56, v56, v57
    v_mfma_f32_16x16x32_bf16 v[28:31], v[156:159], v[152:155], v[28:31]
    v_cvt_pk_bf16_f32 v57, v58, v59
    buffer_store_dwordx2 v[56:57], v1, s[40:43], s61 offen offset:3072
    v_cvt_pk_bf16_f32 v4, v4, v5
    v_cvt_pk_bf16_f32 v5, v6, v7
    buffer_store_dwordx2 v[4:5], v1, s[40:43], s80 offen offset:0
    v_cvt_pk_bf16_f32 v8, v8, v9
    v_cvt_pk_bf16_f32 v9, v10, v11
    buffer_store_dwordx2 v[8:9], v1, s[40:43], s80 offen offset:512
    v_cvt_pk_bf16_f32 v12, v12, v13
    v_cvt_pk_bf16_f32 v13, v14, v15
    buffer_store_dwordx2 v[12:13], v1, s[40:43], s80 offen offset:1024
    v_cvt_pk_bf16_f32 v16, v16, v17
    v_cvt_pk_bf16_f32 v17, v18, v19
    buffer_store_dwordx2 v[16:17], v1, s[40:43], s80 offen offset:1536
    v_cvt_pk_bf16_f32 v20, v20, v21
    v_cvt_pk_bf16_f32 v21, v22, v23
    buffer_store_dwordx2 v[20:21], v1, s[40:43], s80 offen offset:2048
    v_cvt_pk_bf16_f32 v24, v24, v25
    v_cvt_pk_bf16_f32 v25, v26, v27
    buffer_store_dwordx2 v[24:25], v1, s[40:43], s80 offen offset:2560
    v_cvt_pk_bf16_f32 v28, v28, v29
    v_cvt_pk_bf16_f32 v29, v30, v31
    buffer_store_dwordx2 v[28:29], v1, s[40:43], s80 offen offset:3072
    ds_write_b64 v2, v[32:33] offset:3584
    ds_write_b64 v2, v[4:5] offset:0
    v_mfma_f32_16x16x32_bf16 v[60:63], v[88:91], v[124:127], v[60:63]
    ds_write_b64 v2, v[36:37] offset:4096
    ds_write_b64 v2, v[8:9] offset:512
    v_mfma_f32_16x16x32_bf16 v[64:67], v[92:95], v[124:127], v[64:67]
    ds_write_b64 v2, v[40:41] offset:4608
    ds_write_b64 v2, v[12:13] offset:1024
    v_mfma_f32_16x16x32_bf16 v[68:71], v[96:99], v[124:127], v[68:71]
    ds_write_b64 v2, v[44:45] offset:5120
    ds_write_b64 v2, v[16:17] offset:1536
    v_mfma_f32_16x16x32_bf16 v[72:75], v[100:103], v[124:127], v[72:75]
    ds_write_b64 v2, v[48:49] offset:5632
    ds_write_b64 v2, v[20:21] offset:2048
    v_mfma_f32_16x16x32_bf16 v[76:79], v[104:107], v[124:127], v[76:79]
    ds_write_b64 v2, v[52:53] offset:6144
    ds_write_b64 v2, v[24:25] offset:2560
    v_mfma_f32_16x16x32_bf16 v[80:83], v[108:111], v[124:127], v[80:83]
    v_mov_b32 v1, 0
    v_mov_b32 v3, 1
    s_mov_b64 exec, 1
    s_waitcnt vmcnt(0)
    buffer_store_dword v3, v1, s[40:43], s70 offen
    s_mov_b64 exec, -1
    ds_write_b64 v2, v[56:57] offset:6656
    ds_write_b64 v2, v[28:29] offset:3072
    v_mfma_f32_16x16x32_bf16 v[84:87], v[112:115], v[124:127], v[84:87]
    v_mov_b32 v6, 159744
    v_mov_b32_e64 v7, 1
    s_mov_b64 exec, 1
    ds_add_u32 v6, v7
    s_mov_b64 exec, -1
    s_branch L_dumped
L_nosend:
    v_mfma_f32_16x16x32_bf16 v[16:19], v[116:119], v[100:103], v[16:19]
    v_cvt_pk_bf16_f32 v32, v32, v33
    v_mfma_f32_16x16x32_bf16 v[20:23], v[116:119], v[104:107], v[20:23]
    v_cvt_pk_bf16_f32 v33, v34, v35
    ds_write_b64 v2, v[32:33] offset:3584
    v_mfma_f32_16x16x32_bf16 v[24:27], v[116:119], v[108:111], v[24:27]
    v_cvt_pk_bf16_f32 v36, v36, v37
    v_cvt_pk_bf16_f32 v37, v38, v39
    v_mfma_f32_16x16x32_bf16 v[28:31], v[116:119], v[112:115], v[28:31]
    ds_write_b64 v2, v[36:37] offset:4096
    v_cvt_pk_bf16_f32 v40, v40, v41
    v_mfma_f32_16x16x32_bf16 v[4:7], v[156:159], v[128:131], v[4:7]
    v_cvt_pk_bf16_f32 v41, v42, v43
    ds_write_b64 v2, v[40:41] offset:4608
    v_mfma_f32_16x16x32_bf16 v[8:11], v[156:159], v[132:135], v[8:11]
    v_cvt_pk_bf16_f32 v44, v44, v45
    v_cvt_pk_bf16_f32 v45, v46, v47
    v_mfma_f32_16x16x32_bf16 v[12:15], v[156:159], v[136:139], v[12:15]
    ds_write_b64 v2, v[44:45] offset:5120
    v_cvt_pk_bf16_f32 v48, v48, v49
    v_mfma_f32_16x16x32_bf16 v[16:19], v[156:159], v[140:143], v[16:19]
    v_cvt_pk_bf16_f32 v49, v50, v51
    ds_write_b64 v2, v[48:49] offset:5632
    v_mfma_f32_16x16x32_bf16 v[20:23], v[156:159], v[144:147], v[20:23]
    v_cvt_pk_bf16_f32 v52, v52, v53
    v_cvt_pk_bf16_f32 v53, v54, v55
    v_mfma_f32_16x16x32_bf16 v[24:27], v[156:159], v[148:151], v[24:27]
    ds_write_b64 v2, v[52:53] offset:6144
    v_cvt_pk_bf16_f32 v56, v56, v57
    v_mfma_f32_16x16x32_bf16 v[28:31], v[156:159], v[152:155], v[28:31]
    v_cvt_pk_bf16_f32 v57, v58, v59
    ds_write_b64 v2, v[56:57] offset:6656
    v_cvt_pk_bf16_f32 v4, v4, v5
    v_cvt_pk_bf16_f32 v5, v6, v7
    ds_write_b64 v2, v[4:5] offset:0
    v_mfma_f32_16x16x32_bf16 v[60:63], v[88:91], v[124:127], v[60:63]
    v_cvt_pk_bf16_f32 v8, v8, v9
    v_cvt_pk_bf16_f32 v9, v10, v11
    ds_write_b64 v2, v[8:9] offset:512
    v_mfma_f32_16x16x32_bf16 v[64:67], v[92:95], v[124:127], v[64:67]
    v_cvt_pk_bf16_f32 v12, v12, v13
    v_cvt_pk_bf16_f32 v13, v14, v15
L_pg2:
    s_cbranch_execz L_hopret
    ds_write_b64 v2, v[12:13] offset:1024
    v_mfma_f32_16x16x32_bf16 v[68:71], v[96:99], v[124:127], v[68:71]
    v_cvt_pk_bf16_f32 v16, v16, v17
    v_cvt_pk_bf16_f32 v17, v18, v19
    ds_write_b64 v2, v[16:17] offset:1536
    v_mfma_f32_16x16x32_bf16 v[72:75], v[100:103], v[124:127], v[72:75]
    v_cvt_pk_bf16_f32 v20, v20, v21
    v_cvt_pk_bf16_f32 v21, v22, v23
    ds_write_b64 v2, v[20:21] offset:2048
    v_mfma_f32_16x16x32_bf16 v[76:79], v[104:107], v[124:127], v[76:79]
    v_cvt_pk_bf16_f32 v24, v24, v25
    v_cvt_pk_bf16_f32 v25, v26, v27
    ds_write_b64 v2, v[24:25] offset:2560
    v_mfma_f32_16x16x32_bf16 v[80:83], v[108:111], v[124:127], v[80:83]
    v_cvt_pk_bf16_f32 v28, v28, v29
    v_cvt_pk_bf16_f32 v29, v30, v31
    ds_write_b64 v2, v[28:29] offset:3072
    v_mfma_f32_16x16x32_bf16 v[84:87], v[112:115], v[124:127], v[84:87]
    v_mov_b32 v6, 159744
    v_mov_b32_e64 v7, 1
    s_mov_b64 exec, 1
    ds_add_u32 v6, v7
    s_mov_b64 exec, -1
L_dumped:
    v_mfma_f32_16x16x32_bf16 v[60:63], v[128:131], v[164:167], v[60:63]
    v_and_b32 v120, 8, v0
    v_lshlrev_b32_e64 v120, 6, v120
    v_mfma_f32_16x16x32_bf16 v[64:67], v[132:135], v[164:167], v[64:67]
    v_lshlrev_b32_e64 v122, 5, v0
    v_bfi_b32 v122, v122, 0, v120
    v_mfma_f32_16x16x32_bf16 v[68:71], v[136:139], v[164:167], v[68:71]
    s_bitcmp1_b32 s52, 0
    s_cselect_b32 s63, -1, 0
    v_mfma_f32_16x16x32_bf16 v[72:75], v[140:143], v[164:167], v[72:75]
    ds_read_b32 v3, v6
    v_and_b32 v121, s63, v120
    v_and_b32 v123, s63, v122
    v_mfma_f32_16x16x32_bf16 v[76:79], v[144:147], v[164:167], v[76:79]
    v_sub_u32 v120, v251, v120
    v_sub_u32 v121, v251, v121
    v_mfma_f32_16x16x32_bf16 v[80:83], v[148:151], v[164:167], v[80:83]
    v_sub_u32 v122, v252, v122
    v_sub_u32 v123, v252, v123
    v_mfma_f32_16x16x32_bf16 v[84:87], v[152:155], v[164:167], v[84:87]
    v_mov_b32 v124, 159744
    v_mov_b32_e64 v126, 1
    s_mov_b32 s62, 0x3ea52b5c
    s_mov_b32 s63, 0x3ea52b5c
    s_cmp_lg_u32 s70, s81
    s_cbranch_scc1 L_send1
L_sent:
    s_waitcnt lgkmcnt(0)
    v_cmp_gt_u32_e64 vcc, 4, v3
    s_cbranch_vccz L_cw_ok
L_cw_c:
    ds_read_b32 v3, v6
    s_waitcnt lgkmcnt(0)
    v_cmp_gt_u32_e64 vcc, 4, v3
    s_cbranch_vccnz L_cw_c
L_cw_ok:
L_units:
    ds_read_b64 v[144:145], v123 offset:3584
    ds_read_b64 v[146:147], v122 offset:4096
    ds_read_b64 v[148:149], v122 offset:4608
    ds_read_b64 v[150:151], v122 offset:5120
    s_mov_b32 exec_lo, 0xff0000ff
    s_mov_b32 exec_hi, 0
    ds_read_b64 v[216:217], v252 offset:0
    ds_read_b64 v[218:219], v252 offset:512
    ds_read_b64 v[220:221], v252 offset:1024
    ds_read_b64 v[222:223], v252 offset:1536
    s_mov_b32 exec_lo, 0x00ff00ff
    s_mov_b32 exec_hi, exec_lo
    ds_read_b64 v[200:201], v251 offset:0
    ds_read_b64 v[204:205], v251 offset:512
    ds_read_b64 v[208:209], v251 offset:1024
    ds_read_b64 v[212:213], v251 offset:1536
    s_not_b64 exec, exec
    ds_read_b64 v[202:203], v251 offset:0
    ds_read_b64 v[206:207], v251 offset:512
    ds_read_b64 v[210:211], v251 offset:1024
    ds_read_b64 v[214:215], v251 offset:1536
    s_mov_b64 exec, -1
    s_waitcnt lgkmcnt(8)
    v_mfma_f32_16x16x16_bf16 v[4:7], v[144:145], v[216:217], v[244:247]
    ds_read_b64 v[128:129], v121 offset:3584
    ds_read_b64 v[130:131], v251 offset:3584
    v_mfma_f32_16x16x16_bf16 v[8:11], v[146:147], v[218:219], v[240:243]
    ds_read_b64 v[132:133], v120 offset:4096
    ds_read_b64 v[134:135], v251 offset:4096
    v_mfma_f32_16x16x16_bf16 v[12:15], v[148:149], v[220:221], v[240:243]
    ds_read_b64 v[136:137], v120 offset:4608
    ds_read_b64 v[138:139], v251 offset:4608
    v_mfma_f32_16x16x16_bf16 v[16:19], v[150:151], v[222:223], v[240:243]
    ds_read_b64 v[140:141], v120 offset:5120
    ds_read_b64 v[142:143], v251 offset:5120
    s_waitcnt lgkmcnt(6)
    v_mfma_f32_16x16x32_bf16 v[4:7], v[128:131], v[200:203], v[4:7]
    s_waitcnt lgkmcnt(4)
    v_mfma_f32_16x16x32_bf16 v[8:11], v[132:135], v[204:207], v[8:11]
    s_waitcnt lgkmcnt(2)
    v_mfma_f32_16x16x32_bf16 v[12:15], v[136:139], v[208:211], v[12:15]
    s_waitcnt lgkmcnt(0)
    v_mfma_f32_16x16x32_bf16 v[16:19], v[140:143], v[212:215], v[16:19]
    s_nop 1
    v_max3_f32 v36, v4, v5, v6
    s_nop 0
    v_max3_f32 v37, v8, v9, v10
    s_nop 0
    v_max3_f32 v38, v12, v13, v14
    s_nop 0
    v_max3_f32 v39, v16, v17, v18
    v_max_f32 v36, v36, v7
    v_max_f32 v37, v37, v11
    v_max_f32 v38, v38, v15
    v_max_f32 v39, v39, v19
    v_permlane32_swap_b32 v36, v37
    s_nop 0
    v_permlane32_swap_b32 v38, v39
    v_max_f32 v36, v36, v37
    v_max_f32 v38, v38, v39
    s_nop 1
    v_permlane16_swap_b32 v36, v38
    v_max_f32 v36, v36, v38
    v_mul_f32 v38, s62, v36
    v_mul_f32 v36, s62, v36
    s_nop 1
    v_permlane16_swap_b32 v36, v38
    v_mov_b32 v37, v36
    v_mov_b32 v39, v38
    s_nop 0
    v_permlane32_swap_b32 v36, v37
    v_permlane32_swap_b32 v38, v39
    v_pk_fma_f32 v[4:5], v[4:5], s[62:63], v[36:37] op_sel_hi:[1,1,0] neg_lo:[0,0,1] neg_hi:[0,0,1]
    v_pk_fma_f32 v[6:7], v[6:7], s[62:63], v[36:37] op_sel_hi:[1,1,0] neg_lo:[0,0,1] neg_hi:[0,0,1]
    v_pk_fma_f32 v[8:9], v[8:9], s[62:63], v[36:37] op_sel:[0,0,1] op_sel_hi:[1,1,1] neg_lo:[0,0,1] neg_hi:[0,0,1]
    v_pk_fma_f32 v[10:11], v[10:11], s[62:63], v[36:37] op_sel:[0,0,1] op_sel_hi:[1,1,1] neg_lo:[0,0,1] neg_hi:[0,0,1]
    v_pk_fma_f32 v[12:13], v[12:13], s[62:63], v[38:39] op_sel_hi:[1,1,0] neg_lo:[0,0,1] neg_hi:[0,0,1]
    v_pk_fma_f32 v[14:15], v[14:15], s[62:63], v[38:39] op_sel_hi:[1,1,0] neg_lo:[0,0,1] neg_hi:[0,0,1]
    v_pk_fma_f32 v[16:17], v[16:17], s[62:63], v[38:39] op_sel:[0,0,1] op_sel_hi:[1,1,1] neg_lo:[0,0,1] neg_hi:[0,0,1]
    v_pk_fma_f32 v[18:19], v[18:19], s[62:63], v[38:39] op_sel:[0,0,1] op_sel_hi:[1,1,1] neg_lo:[0,0,1] neg_hi:[0,0,1]
    v_exp_f32 v4, v4
    v_exp_f32 v5, v5
    v_exp_f32 v6, v6
    v_exp_f32 v7, v7
    v_exp_f32 v8, v8
    v_exp_f32 v9, v9
    v_exp_f32 v10, v10
    v_exp_f32 v11, v11
    v_exp_f32 v12, v12
    v_exp_f32 v13, v13
    v_exp_f32 v14, v14
    v_exp_f32 v15, v15
    v_exp_f32 v16, v16
    v_exp_f32 v17, v17
    v_exp_f32 v18, v18
    v_exp_f32 v19, v19
    v_pk_add_f32 v[20:21], v[4:5], v[6:7]
    v_pk_add_f32 v[22:23], v[8:9], v[10:11]
    v_pk_add_f32 v[24:25], v[12:13], v[14:15]
    v_pk_add_f32 v[26:27], v[16:17], v[18:19]
    v_add_f32 v36, v20, v21
    v_add_f32 v37, v22, v23
    v_add_f32 v38, v24, v25
    v_add_f32 v39, v26, v27
    v_permlane32_swap_b32 v36, v37
    s_nop 0
    v_permlane32_swap_b32 v38, v39
    v_add_f32 v36, v36, v37
    v_add_f32 v38, v38, v39
    s_nop 1
    v_permlane16_swap_b32 v36, v38
    v_add_f32 v36, v36, v38
    v_rcp_f32 v38, v36
    v_rcp_f32 v36, v36
    s_nop 1
    v_permlane16_swap_b32 v36, v38
    v_mov_b32 v37, v36
    v_mov_b32_e64 v39, v38
    s_nop 0
    v_permlane32_swap_b32 v36, v37
    v_permlane32_swap_b32 v38, v39
    v_pk_mul_f32 v[4:5], v[4:5], v[36:37] op_sel_hi:[1,0]
    v_pk_mul_f32 v[6:7], v[6:7], v[36:37] op_sel_hi:[1,0]
    v_cvt_pk_bf16_f32 v20, v4, v5
    v_cvt_pk_bf16_f32 v21, v6, v7
    ds_write_b64 v254, v[20:21] offset:0
    v_pk_mul_f32 v[8:9], v[8:9], v[36:37] op_sel:[0,1] op_sel_hi:[1,1]
    v_pk_mul_f32 v[10:11], v[10:11], v[36:37] op_sel:[0,1] op_sel_hi:[1,1]
    v_cvt_pk_bf16_f32 v22, v8, v9
    v_cvt_pk_bf16_f32 v23, v10, v11
    ds_write_b64 v254, v[22:23] offset:1024
    v_pk_mul_f32 v[12:13], v[12:13], v[38:39] op_sel_hi:[1,0]
    v_pk_mul_f32 v[14:15], v[14:15], v[38:39] op_sel_hi:[1,0]
    v_cvt_pk_bf16_f32 v24, v12, v13
    v_cvt_pk_bf16_f32 v25, v14, v15
    ds_write_b64 v254, v[24:25] offset:2048
    v_pk_mul_f32 v[16:17], v[16:17], v[38:39] op_sel:[0,1] op_sel_hi:[1,1]
    v_pk_mul_f32 v[18:19], v[18:19], v[38:39] op_sel:[0,1] op_sel_hi:[1,1]
    v_cvt_pk_bf16_f32 v26, v16, v17
    v_cvt_pk_bf16_f32 v27, v18, v19
    ds_write_b64 v254, v[26:27] offset:3072
    s_mov_b64 exec, 1
    ds_add_u32 v124, v126 offset:4
    s_mov_b64 exec, -1
    s_cmp_ge_u32 s52, 4
    s_cbranch_scc0 L_cbeta
    s_setprio 0
    s_sub_u32 m0, s67, 81920
    s_add_u32 s68, s22, 0
    buffer_load_dwordx4 v43, s[36:39], s68 offen lds
    s_sub_u32 m0, s67, 77824
    s_add_u32 s68, s22, 40960
    buffer_load_dwordx4 v43, s[36:39], s68 offen lds
    s_sub_u32 m0, s67, 73728
    s_add_u32 s68, s23, 0
    buffer_load_dwordx4 v43, s[36:39], s68 offen lds
    s_sub_u32 m0, s67, 69632
    s_add_u32 s68, s23, 40960
    buffer_load_dwordx4 v43, s[36:39], s68 offen lds
    s_sub_u32 m0, s67, 65536
    s_add_u32 s68, s24, 0
    buffer_load_dwordx4 v43, s[36:39], s68 offen lds
    s_sub_u32 m0, s67, 61440
    s_add_u32 s68, s24, 40960
    buffer_load_dwordx4 v43, s[36:39], s68 offen lds
    s_sub_u32 m0, s67, 57344
    s_add_u32 s68, s25, 0
    buffer_load_dwordx4 v43, s[36:39], s68 offen lds
    s_sub_u32 m0, s67, 53248
    s_add_u32 s68, s25, 40960
    buffer_load_dwordx4 v43, s[36:39], s68 offen lds
    s_branch L_lbeta
L_cbeta:
    s_mov_b64 exec, s[66:67]
    s_nop 0
    v_cvt_pk_bf16_f32 v170, v60, v61
    v_cvt_pk_bf16_f32 v171, v62, v63
    v_cvt_pk_bf16_f32 v172, v64, v65
    v_cvt_pk_bf16_f32 v173, v66, v67
    v_cvt_pk_bf16_f32 v174, v68, v69
    v_cvt_pk_bf16_f32 v175, v70, v71
    v_cvt_pk_bf16_f32 v176, v72, v73
    v_cvt_pk_bf16_f32 v177, v74, v75
    v_cvt_pk_bf16_f32 v178, v76, v77
    v_cvt_pk_bf16_f32 v179, v78, v79
    v_cvt_pk_bf16_f32 v180, v80, v81
    v_cvt_pk_bf16_f32 v181, v82, v83
    v_cvt_pk_bf16_f32 v182, v84, v85
    v_cvt_pk_bf16_f32 v183, v86, v87
    s_not_b64 exec, exec
    s_nop 0
    v_cvt_pk_bf16_f32 v186, v60, v61
    v_cvt_pk_bf16_f32 v187, v62, v63
    v_cvt_pk_bf16_f32 v188, v64, v65
    v_cvt_pk_bf16_f32 v189, v66, v67
    v_cvt_pk_bf16_f32 v190, v68, v69
    v_cvt_pk_bf16_f32 v191, v70, v71
    v_cvt_pk_bf16_f32 v192, v72, v73
    v_cvt_pk_bf16_f32 v193, v74, v75
    v_cvt_pk_bf16_f32 v194, v76, v77
    v_cvt_pk_bf16_f32 v195, v78, v79
    v_cvt_pk_bf16_f32 v196, v80, v81
    v_cvt_pk_bf16_f32 v197, v82, v83
    v_cvt_pk_bf16_f32 v198, v84, v85
    v_cvt_pk_bf16_f32 v199, v86, v87
    s_mov_b64 exec, -1
    s_cmp_eq_u32 s75, 0
    s_cbranch_scc1 L_keypoll
L_keyok:
    v_and_b32 v77, 15, v0
    v_lshlrev_b32 v1, 2, v77
    s_lshl_b32 s79, s52, 5
    s_add_u32 s79, s79, s60
    s_lshl_b32 s67, s55, 10
    s_add_u32 s67, s67, s79
    s_lshl_b32 s67, s67, 2
    s_add_u32 s67, s67, 5963776
    v_add3_u32 v2, s79, v77, 0
    v_and_b32 v2, 0x400, v2
    v_lshl_or_b32 v78, v2, 21, v1
    buffer_load_dword v86, v78, s[40:43], s67 offen offset:0 sc1
    v_add3_u32 v2, s79, v77, 16
    v_and_b32 v2, 0x400, v2
    v_lshl_or_b32 v79, v2, 21, v1
    buffer_load_dword v87, v79, s[40:43], s67 offen offset:64 sc1
    v_and_b32_e64 v2, 32, v0
    v_lshl_add_u32 v125, v2, 4, v255
    v_add_u32 v1, s82, v255
    v_add_u32 v2, s83, v255
    s_add_u32 s63, s54, 4096
    s_add_u32 s68, s54, 143360
    s_add_u32 s69, s63, 143360
L_pw_c:
    ds_read_b32 v127, v124 offset:4
    s_waitcnt lgkmcnt(0)
    v_bfi_b32 v127, v127, 0, s84
    v_cmp_ne_u32_e64 vcc, 0, v127
    s_cbranch_vccnz L_pw_c
    ds_read_b128 v[88:91], v1 offset:0
    ds_read_b128 v[128:131], v2 offset:0
    ds_read_b128 v[92:95], v1 offset:1024
    ds_read_b128 v[132:135], v2 offset:1024
    ds_read_b128 v[96:99], v1 offset:2048
    ds_read_b128 v[136:139], v2 offset:2048
    ds_read_b128 v[100:103], v1 offset:3072
    ds_read_b128 v[140:143], v2 offset:3072
    ds_read_b128 v[104:107], v1 offset:4096
    ds_read_b128 v[144:147], v2 offset:4096
    ds_read_b128 v[108:111], v1 offset:5120
    ds_read_b128 v[148:151], v2 offset:5120
    ds_read_b128 v[112:115], v1 offset:6144
    ds_read_b128 v[152:155], v2 offset:6144
    s_lshr_b32 s70, s52, 1
    s_mul_i32 s70, s70, 6144
    s_lshl_b32 s61, s52, 9
    s_add_u32 s70, s70, s61
    s_add_u32 s70, s70, 38912
    v_add_u32_e64 v83, s70, v125
    s_lshl_b32 s70, s52, 2
    s_add_u32 s70, s70, 159760
    v_mov_b32 v84, s70
    s_waitcnt lgkmcnt(12)
    v_mfma_f32_16x16x32_bf16 v[4:7], v[168:171], v[88:91], 0
    v_mfma_f32_16x16x32_bf16 v[4:7], v[184:187], v[128:131], v[4:7]
    s_waitcnt lgkmcnt(10)
    v_mfma_f32_16x16x32_bf16 v[8:11], v[170:173], v[92:95], 0
    v_mfma_f32_16x16x32_bf16 v[8:11], v[186:189], v[132:135], v[8:11]
    s_waitcnt lgkmcnt(8)
    v_mfma_f32_16x16x32_bf16 v[12:15], v[172:175], v[96:99], 0
    v_mfma_f32_16x16x32_bf16 v[12:15], v[188:191], v[136:139], v[12:15]
    s_waitcnt lgkmcnt(6)
    v_mfma_f32_16x16x32_bf16 v[16:19], v[174:177], v[100:103], 0
    v_cvt_pk_bf16_f32 v60, v4, v5
    v_mfma_f32_16x16x32_bf16 v[16:19], v[190:193], v[140:143], v[16:19]
    v_cvt_pk_bf16_f32 v61, v6, v7
    s_waitcnt lgkmcnt(4)
    v_mfma_f32_16x16x32_bf16 v[20:23], v[176:179], v[104:107], 0
    v_cvt_pk_bf16_f32 v62, v8, v9
    v_mfma_f32_16x16x32_bf16 v[20:23], v[192:195], v[144:147], v[20:23]
    v_cvt_pk_bf16_f32 v63, v10, v11
    s_waitcnt lgkmcnt(2)
    v_mfma_f32_16x16x32_bf16 v[24:27], v[178:181], v[108:111], 0
    v_permlane32_swap_b32 v60, v62
    v_mfma_f32_16x16x32_bf16 v[24:27], v[194:197], v[148:151], v[24:27]
    v_permlane32_swap_b32 v61, v63
    s_mov_b32 exec_lo, 0xff00ff00
    s_waitcnt lgkmcnt(0)
    v_mfma_f32_16x16x32_bf16 v[28:31], v[180:183], v[112:115], 0
    buffer_store_dwordx4 v[60:63], v125, s[40:43], s68 offen offset:0 sc1
    v_mfma_f32_16x16x32_bf16 v[28:31], v[196:199], v[152:155], v[28:31]
    s_mov_b32 exec_lo, -1
    s_nop 0
    v_cvt_pk_bf16_f32 v64, v12, v13
    v_cvt_pk_bf16_f32 v65, v14, v15
    v_cvt_pk_bf16_f32 v66, v16, v17
    v_cvt_pk_bf16_f32 v67, v18, v19
    v_cvt_pk_bf16_f32 v68, v20, v21
    v_cvt_pk_bf16_f32 v69, v22, v23
    v_permlane32_swap_b32 v64, v66
    v_permlane32_swap_b32 v65, v67
    buffer_store_dwordx4 v[64:67], v125, s[40:43], s68 offen offset:2048 sc1
    v_cvt_pk_bf16_f32 v70, v24, v25
    v_cvt_pk_bf16_f32 v71, v26, v27
    v_cvt_pk_bf16_f32 v72, v28, v29
    v_cvt_pk_bf16_f32 v73, v30, v31
    v_permlane32_swap_b32 v68, v70
    v_permlane32_swap_b32 v69, v71
    buffer_store_dwordx4 v[68:71], v125, s[40:43], s69 offen offset:0 sc1
    v_permlane32_swap_b32 v72, v74
    v_permlane32_swap_b32 v73, v75
    s_mov_b32 exec_hi, 0
    buffer_store_dwordx4 v[72:75], v125, s[40:43], s69 offen offset:2048 sc1
    s_mov_b32 s84, 0x20200
L_pw_c2:
    ds_read_b32 v127, v124 offset:4
    s_waitcnt lgkmcnt(0)
    v_bfi_b32 v127, v127, 0, s84
    v_cmp_ne_u32 vcc, 0, v127
    s_cbranch_vccnz L_pw_c2
    ds_write_b128 v83, v[72:75] offset:6144
    s_mov_b32 exec_hi, -1
    ds_write_b128 v83, v[60:63] offset:0
    ds_write_b128 v83, v[64:67] offset:2048
    ds_write_b128 v83, v[68:71] offset:4096
    s_waitcnt lgkmcnt(0)
    s_barrier
    v_mov_b32 v1, 0
    v_mov_b32_e64 v3, 1
    s_lshl1_add_u32 s63, s52, s53
    s_cmp_eq_u32 s63, 1
    s_mov_b64 exec, 1
    s_waitcnt vmcnt(0)
    s_barrier
    s_cbranch_scc0 L_nosig2
    buffer_store_dword v3, v1, s[40:43], s20 offen offset:8
L_nosig2:
    s_cmp_eq_u32 s52, 1
    s_cbranch_scc0 L_nosig3
    s_atomic_add s78, s[72:73], 286848
    s_atomic_add s78, s[72:73], 287104
    s_atomic_add s78, s[72:73], 287360
    s_atomic_add s78, s[72:73], 287616
    s_atomic_add s78, s[72:73], 287872
L_nosig3:
    s_cmp_eq_u32 s63, 0
    s_cbranch_scc0 L_cfin
    buffer_store_dword v3, v1, s[40:43], s20 offen offset:8 sc1
    s_branch L_cfin
    s_nop 0
L_lbeta:
    s_mul_i32 s63, s59, 290816
    s_lshl_b32 s61, s64, 11
    s_add_u32 s63, s63, s61
    v_add_u32 v224, s63, v255
    s_cmp_eq_u32 s64, 3
    s_cselect_b32 s63, 0x80000000, 0
    s_add_u32 s63, s63, 1024
    v_add_u32_e64 v225, s63, v224
    s_cmp_eq_u32 s64, 0
    s_cselect_b32 s63, 8, 0
    v_bfi_b32 v8, v0, 0, s63
    v_lshl_or_b32 v224, v8, 28, v224
    v_add_u32 v226, 7168, v224
    v_add_u32 v227, 7168, v225
    v_bfe_u32 v8, v0, 3, 2
    v_lshlrev_b32 v8, 5, v8
    v_and_b32 v9, 3, v0
    v_lshl_add_u32 v8, v9, 3, v8
    v_lshrrev_b32_e64 v9, 2, v0
    v_lshl_add_u32 v8, v9, 7, v8
    v_and_b32_e64 v9, 32, v0
    v_lshl_add_u32 v8, v9, 5, v8
    v_add_u32 v232, 81920, v8
    v_xor_b32 v233, 32, v232
    v_xor_b32 v234, 64, v232
    v_xor_b32 v235, 96, v232
    s_lshl_b32 s63, s56, 8
    s_sub_u32 s63, s20, s63
    v_and_b32 v8, 3, v0
    v_cmp_le_u32 vcc, s56, v8
    s_nop 1
    v_addc_co_u32 v8, vcc, 0, v8, vcc
    v_lshl_add_u32 v228, v8, 8, s63
    s_mul_i32 s63, s64, 4608
    s_add_u32 s63, s63, 131072
    v_and_b32_e64 v8, 15, v0
    v_mul_u32_u24 v8, 144, v8
    v_lshrrev_b32_e64 v9, 4, v0
    v_lshl_add_u32 v8, v9, 3, v8
    v_add_u32_e64 v236, s63, v8
    v_mul_u32_u24 v8, 144, v1
    v_lshl_add_u32 v8, v2, 4, v8
    v_add_u32_e64 v237, s63, v8
    s_mul_i32 s63, s64, 9216
    s_add_u32 s63, s63, 38912
    v_add_u32_e64 v238, s63, v255
    v_mul_u32_u24 v8, 2560, v1
    v_lshl_add_u32 v239, v2, 4, v8
    s_lshl_b32 s84, s64, 5
    s_add_u32 s63, s84, s60
    s_lshl1_add_u32 s63, s63, s55
    s_mul_i32 s63, s63, 1280
    s_lshl_b32 s61, s58, 7
    s_add_u32 s63, s63, s61
    s_cmp_eq_u32 s57, 4
    s_cselect_b32 s61, 0, 8
    s_add_u32 s61, s61, 96
    s_sub_u32 s84, s84, 8
    s_cmp_lt_u32 s84, s61
    s_cselect_b32 s82, s63, 0x80000000
    v_add_u32_e64 v229, s82, v239
    s_add_u32 s84, s84, 8
    s_add_u32 s63, s63, 20480
    s_cmp_lt_u32 s84, s61
    s_cselect_b32 s82, s63, 0x80000000
    v_add_u32_e64 v230, s82, v239
    s_add_u32 s84, s84, 8
    s_add_u32 s63, s63, 20480
    s_cmp_lt_u32 s84, s61
    s_cselect_b32 s82, s63, 0x80000000
    v_add_u32_e64 v231, s82, v239
    s_add_u32 s84, s84, 8
    s_add_u32 s63, s63, 20480
    s_cmp_lt_u32 s84, s61
    s_cselect_b32 s82, s63, 0x80000000
    v_add_u32_e64 v250, s82, v239
    s_sub_u32 s82, s58, s56
    s_mul_i32 s82, s82, 14336
    s_add_u32 s63, s82, 143360
    s_sub_u32 s61, 215040, s82
    s_add_u32 s83, s56, 0
    s_cmp_ge_u32 s83, 5
    s_cselect_b32 s21, 5, 0
    s_sub_u32 s83, s83, s21
    s_mul_i32 s83, s83, 14336
    s_add_u32 s72, s63, s83
    s_cmp_lt_u32 s56, 1
    s_cselect_b32 s83, 1, 0
    s_mul_i32 s83, s83, 14336
    s_add_u32 s73, s63, s83
    s_cmp_lt_u32 s56, 2
    s_cselect_b32 s83, 2, 1
    s_mul_i32 s83, s83, 14336
    s_add_u32 s74, s63, s83
    s_cmp_lt_u32 s56, 3
    s_cselect_b32 s83, 3, 2
    s_mul_i32 s83, s83, 14336
    s_add_u32 s75, s63, s83
    s_cmp_lt_u32 s56, 4
    s_cselect_b32 s83, 4, 3
    s_mul_i32 s83, s83, 14336
    s_add_u32 s76, s63, s83
    s_mov_b32 s83, 0
    s_mul_i32 s83, s83, 14336
    s_add_u32 s77, s61, s83
    s_mov_b32 s83, 1
    s_mul_i32 s83, s83, 14336
    s_add_u32 s78, s61, s83
    s_mov_b32 s83, 2
    s_mul_i32 s83, s83, 14336
    s_add_u32 s79, s61, s83
    s_mov_b32 s83, 3
    s_mul_i32 s83, s83, 14336
    s_add_u32 s80, s61, s83
    s_mov_b32 s83, 4
    s_mul_i32 s83, s83, 14336
    s_add_u32 s81, s61, s83
    s_mov_b32 s84, 0x20200
L_pw_l:
    ds_read_b32 v127, v124 offset:4
    s_waitcnt lgkmcnt(0)
    v_bfi_b32 v127, v127, 0, s84
    v_cmp_ne_u32 vcc, 0, v127
    s_cbranch_vccnz L_pw_l
L_s2:
    ds_read_b64_tr_b16 v[92:93], v232 offset:0
    ds_read_b64_tr_b16 v[94:95], v232 offset:1024
    ds_read_b64_tr_b16 v[96:97], v233 offset:0
    ds_read_b64_tr_b16 v[98:99], v233 offset:1024
    ds_read_b64_tr_b16 v[100:101], v234 offset:0
    ds_read_b64_tr_b16 v[102:103], v234 offset:1024
    ds_read_b64_tr_b16 v[104:105], v235 offset:0
    ds_read_b64_tr_b16 v[106:107], v235 offset:1024
    ds_read_b64_tr_b16 v[108:109], v232 offset:4096
    ds_read_b64_tr_b16 v[110:111], v232 offset:5120
    ds_read_b64_tr_b16 v[112:113], v233 offset:4096
    ds_read_b64_tr_b16 v[114:115], v233 offset:5120
    ds_read_b64_tr_b16 v[116:117], v234 offset:4096
    ds_read_b64_tr_b16 v[118:119], v234 offset:5120
    ds_read_b64_tr_b16 v[120:121], v235 offset:4096
    ds_read_b64_tr_b16 v[122:123], v235 offset:5120
    s_mov_b32 s61, 0
    s_add_u32 s20, s20, 128
    s_lshl_b32 s63, s52, 11
    s_add_u32 s63, s63, 30720
    v_add_u32 v3, s63, v255
    s_barrier
    ds_read_b128 v[36:39], v3 offset:0
    ds_read_b128 v[40:43], v3 offset:1024
    ds_read_b128 v[44:47], v3 offset:7168
    ds_read_b128 v[48:51], v3 offset:8192
    s_lshl_b32 s63, s52, 2
    s_add_u32 s63, s63, 159744
    v_mov_b32 v3, s63
    s_mov_b32 s21, 0
    s_waitcnt lgkmcnt(0)
    v_mfma_f32_16x16x32_bf16 v[4:7], v[92:95], v[36:39], 0
    v_mfma_f32_16x16x32_bf16 v[8:11], v[96:99], v[36:39], 0
    v_mfma_f32_16x16x32_bf16 v[12:15], v[100:103], v[36:39], 0
    v_mfma_f32_16x16x32_bf16 v[16:19], v[104:107], v[36:39], 0
    v_mfma_f32_16x16x32_bf16 v[20:23], v[92:95], v[40:43], 0
    v_mfma_f32_16x16x32_bf16 v[24:27], v[96:99], v[40:43], 0
    v_mfma_f32_16x16x32_bf16 v[28:31], v[100:103], v[40:43], 0
    v_mfma_f32_16x16x32_bf16 v[32:35], v[104:107], v[40:43], 0
    v_mfma_f32_16x16x32_bf16 v[4:7], v[108:111], v[44:47], v[4:7]
    v_mfma_f32_16x16x32_bf16 v[8:11], v[112:115], v[44:47], v[8:11]
    v_mfma_f32_16x16x32_bf16 v[12:15], v[116:119], v[44:47], v[12:15]
    v_mfma_f32_16x16x32_bf16 v[16:19], v[120:123], v[44:47], v[16:19]
    v_mfma_f32_16x16x32_bf16 v[20:23], v[108:111], v[48:51], v[20:23]
    v_mfma_f32_16x16x32_bf16 v[24:27], v[112:115], v[48:51], v[24:27]
    v_mfma_f32_16x16x32_bf16 v[28:31], v[116:119], v[48:51], v[28:31]
    v_mfma_f32_16x16x32_bf16 v[32:35], v[120:123], v[48:51], v[32:35]
    ds_read_b64_tr_b16 v[124:125], v232 offset:8192
    ds_read_b64_tr_b16 v[126:127], v232 offset:9216
    ds_read_b64_tr_b16 v[128:129], v233 offset:8192
    ds_read_b64_tr_b16 v[130:131], v233 offset:9216
    ds_read_b64_tr_b16 v[132:133], v234 offset:8192
    ds_read_b64_tr_b16 v[134:135], v234 offset:9216
    ds_read_b64_tr_b16 v[136:137], v235 offset:8192
    ds_read_b64_tr_b16 v[138:139], v235 offset:9216
    s_waitcnt vmcnt(0)
    s_barrier
    s_setprio 1
    s_nop 0
    ds_read_b64_tr_b16 v[140:141], v232 offset:12288
    ds_read_b64_tr_b16 v[142:143], v232 offset:13312
    ds_read_b64_tr_b16 v[144:145], v233 offset:12288
    ds_read_b64_tr_b16 v[146:147], v233 offset:13312
    ds_read_b64_tr_b16 v[148:149], v234 offset:12288
    ds_read_b64_tr_b16 v[150:151], v234 offset:13312
    ds_read_b64_tr_b16 v[152:153], v235 offset:12288
    ds_read_b64_tr_b16 v[154:155], v235 offset:13312
    ds_read_b64_tr_b16 v[156:157], v232 offset:16384
    ds_read_b64_tr_b16 v[158:159], v232 offset:17408
    ds_read_b64_tr_b16 v[160:161], v233 offset:16384
    ds_read_b64_tr_b16 v[162:163], v233 offset:17408
    ds_read_b64_tr_b16 v[164:165], v234 offset:16384
    ds_read_b64_tr_b16 v[166:167], v234 offset:17408
    ds_read_b64_tr_b16 v[168:169], v235 offset:16384
    ds_read_b64_tr_b16 v[170:171], v235 offset:17408
    buffer_load_dword v2, v228, s[40:43], 0 offen offset:8 sc1
    ds_read_b64_tr_b16 v[172:173], v232 offset:20480
    ds_read_b64_tr_b16 v[174:175], v232 offset:21504
    ds_read_b64_tr_b16 v[176:177], v233 offset:20480
    ds_read_b64_tr_b16 v[178:179], v233 offset:21504
    ds_read_b64_tr_b16 v[180:181], v234 offset:20480
    ds_read_b64_tr_b16 v[182:183], v234 offset:21504
    ds_read_b64_tr_b16 v[184:185], v235 offset:20480
    ds_read_b64_tr_b16 v[186:187], v235 offset:21504
    ds_read_b64_tr_b16 v[188:189], v232 offset:24576
    ds_read_b64_tr_b16 v[190:191], v232 offset:25600
    ds_read_b64_tr_b16 v[192:193], v233 offset:24576
    ds_read_b64_tr_b16 v[194:195], v233 offset:25600
    ds_read_b64_tr_b16 v[196:197], v234 offset:24576
    ds_read_b64_tr_b16 v[198:199], v234 offset:25600
    ds_read_b64_tr_b16 v[200:201], v235 offset:24576
    ds_read_b64_tr_b16 v[202:203], v235 offset:25600
    ds_read_b64_tr_b16 v[204:205], v232 offset:28672
    ds_read_b64_tr_b16 v[206:207], v232 offset:29696
    ds_read_b64_tr_b16 v[208:209], v233 offset:28672
    ds_read_b64_tr_b16 v[210:211], v233 offset:29696
    ds_read_b64_tr_b16 v[212:213], v234 offset:28672
    ds_read_b64_tr_b16 v[214:215], v234 offset:29696
    ds_read_b64_tr_b16 v[216:217], v235 offset:28672
    ds_read_b64_tr_b16 v[218:219], v235 offset:29696
    v_subrev_u32 v242, 81920, v232
    v_subrev_u32 v243, 81920, v233
    v_subrev_u32 v244, 81920, v234
    v_subrev_u32 v245, 81920, v235
    buffer_load_dword v1, v228, s[40:43], 0 offen offset:8 sc1
L_pg3:
    s_cbranch_execz L_hopret
    s_waitcnt vmcnt(1)
    v_cmp_eq_u32 vcc, 0, v2
    s_cbranch_vccz L_ook
    buffer_load_dword v2, v228, s[40:43], 0 offen offset:8 sc1
    s_waitcnt vmcnt(1)
    v_cmp_eq_u32 vcc, 0, v1
    s_cbranch_vccz L_ook
    s_waitcnt vmcnt(0)
    v_cmp_eq_u32 vcc, 0, v2
    s_cbranch_vccz L_ook
L_opoll:
    buffer_load_dword v2, v228, s[40:43], 0 offen offset:8 sc1
    s_add_u32 s61, s61, 1
    s_cmp_lt_u32 s61, 30000
    s_waitcnt vmcnt(0)
    v_cmp_eq_u32_e64 vcc, 0, v2
    s_cbranch_scc0 L_ook
    s_cbranch_vccnz L_opoll
L_ook:
    s_cmp_eq_u32 s52, 7
    s_cbranch_scc1 L_ookb
    buffer_load_dwordx4 v[52:55], v224, s[40:43], s73 offen sc1
    buffer_load_dwordx4 v[56:59], v225, s[40:43], s73 offen sc1
    buffer_load_dwordx4 v[60:63], v226, s[40:43], s73 offen sc1
    buffer_load_dwordx4 v[64:67], v227, s[40:43], s73 offen sc1
    ds_read_b64_tr_b16 v[92:93], v232 offset:32768
    ds_read_b64_tr_b16 v[94:95], v232 offset:33792
    ds_read_b64_tr_b16 v[96:97], v233 offset:32768
    ds_read_b64_tr_b16 v[98:99], v233 offset:33792
    ds_read_b64_tr_b16 v[100:101], v234 offset:32768
    ds_read_b64_tr_b16 v[102:103], v234 offset:33792
    ds_read_b64_tr_b16 v[104:105], v235 offset:32768
    ds_read_b64_tr_b16 v[106:107], v235 offset:33792
    ds_read_b64_tr_b16 v[108:109], v232 offset:36864
    ds_read_b64_tr_b16 v[110:111], v232 offset:37888
    ds_read_b64_tr_b16 v[112:113], v233 offset:36864
    ds_read_b64_tr_b16 v[114:115], v233 offset:37888
    ds_read_b64_tr_b16 v[116:117], v234 offset:36864
    ds_read_b64_tr_b16 v[118:119], v234 offset:37888
    ds_read_b64_tr_b16 v[120:121], v235 offset:36864
    ds_read_b64_tr_b16 v[122:123], v235 offset:37888
    buffer_load_dwordx4 v[68:71], v224, s[40:43], s74 offen sc1
    buffer_load_dwordx4 v[72:75], v225, s[40:43], s74 offen sc1
    buffer_load_dwordx4 v[76:79], v226, s[40:43], s74 offen sc1
    buffer_load_dwordx4 v[80:83], v227, s[40:43], s74 offen sc1
    buffer_load_dwordx4 v[84:87], v224, s[40:43], s75 offen sc1
    buffer_load_dwordx4 v[88:91], v225, s[40:43], s75 offen sc1
    buffer_load_dwordx4 v[36:39], v226, s[40:43], s75 offen sc1
    buffer_load_dwordx4 v[40:43], v227, s[40:43], s75 offen sc1
    s_waitcnt lgkmcnt(15)
    s_load_dword s21, s[40:41], s20 glc
    s_waitcnt vmcnt(10)
    v_mfma_f32_16x16x32_bf16 v[4:7], v[124:127], v[52:55], v[4:7]
    v_mfma_f32_16x16x32_bf16 v[8:11], v[128:131], v[52:55], v[8:11]
    v_mfma_f32_16x16x32_bf16 v[12:15], v[132:135], v[52:55], v[12:15]
    v_mfma_f32_16x16x32_bf16 v[16:19], v[136:139], v[52:55], v[16:19]
    v_mfma_f32_16x16x32_bf16 v[20:23], v[124:127], v[56:59], v[20:23]
    v_mfma_f32_16x16x32_bf16 v[24:27], v[128:131], v[56:59], v[24:27]
    s_load_dword s21, s[40:41], s20 glc
    v_mfma_f32_16x16x32_bf16 v[28:31], v[132:135], v[56:59], v[28:31]
    buffer_load_dwordx4 v[44:47], v224, s[40:43], s76 offen sc1
    v_mfma_f32_16x16x32_bf16 v[32:35], v[136:139], v[56:59], v[32:35]
    buffer_load_dwordx4 v[48:51], v225, s[40:43], s76 offen sc1
    s_waitcnt vmcnt(10)
    v_mfma_f32_16x16x32_bf16 v[4:7], v[140:143], v[60:63], v[4:7]
    ds_read_b64_tr_b16 v[124:125], v232 offset:40960
    v_mfma_f32_16x16x32_bf16 v[8:11], v[144:147], v[60:63], v[8:11]
    ds_read_b64_tr_b16 v[126:127], v232 offset:41984
    v_mfma_f32_16x16x32_bf16 v[12:15], v[148:151], v[60:63], v[12:15]
    ds_read_b64_tr_b16 v[128:129], v233 offset:40960
    v_mfma_f32_16x16x32_bf16 v[16:19], v[152:155], v[60:63], v[16:19]
    ds_read_b64_tr_b16 v[130:131], v233 offset:41984
    v_mfma_f32_16x16x32_bf16 v[20:23], v[140:143], v[64:67], v[20:23]
    ds_read_b64_tr_b16 v[132:133], v234 offset:40960
    v_mfma_f32_16x16x32_bf16 v[24:27], v[144:147], v[64:67], v[24:27]
    ds_read_b64_tr_b16 v[134:135], v234 offset:41984
    v_mfma_f32_16x16x32_bf16 v[28:31], v[148:151], v[64:67], v[28:31]
    buffer_load_dwordx4 v[52:55], v226, s[40:43], s76 offen sc1
    v_mfma_f32_16x16x32_bf16 v[32:35], v[152:155], v[64:67], v[32:35]
    buffer_load_dwordx4 v[56:59], v227, s[40:43], s76 offen sc1
    s_waitcnt vmcnt(10)
    v_mfma_f32_16x16x32_bf16 v[4:7], v[156:159], v[68:71], v[4:7]
    ds_read_b64_tr_b16 v[136:137], v235 offset:40960
    v_mfma_f32_16x16x32_bf16 v[8:11], v[160:163], v[68:71], v[8:11]
    ds_read_b64_tr_b16 v[138:139], v235 offset:41984
    v_mfma_f32_16x16x32_bf16 v[12:15], v[164:167], v[68:71], v[12:15]
    ds_read_b64_tr_b16 v[140:141], v232 offset:45056
    v_mfma_f32_16x16x32_bf16 v[16:19], v[168:171], v[68:71], v[16:19]
    ds_read_b64_tr_b16 v[142:143], v232 offset:46080
    v_mfma_f32_16x16x32_bf16 v[20:23], v[156:159], v[72:75], v[20:23]
    ds_read_b64_tr_b16 v[144:145], v233 offset:45056
    v_mfma_f32_16x16x32_bf16 v[24:27], v[160:163], v[72:75], v[24:27]
    ds_read_b64_tr_b16 v[146:147], v233 offset:46080
    s_cmp_ge_u32 s21, 5
    s_cbranch_scc0 L_mb0
L_mb_ret:
    v_mfma_f32_16x16x32_bf16 v[28:31], v[164:167], v[72:75], v[28:31]
    buffer_load_dwordx4 v[60:63], v224, s[40:43], s77 offen sc1
    v_mfma_f32_16x16x32_bf16 v[32:35], v[168:171], v[72:75], v[32:35]
    buffer_load_dwordx4 v[64:67], v225, s[40:43], s77 offen sc1
    s_waitcnt vmcnt(10)
    v_mfma_f32_16x16x32_bf16 v[4:7], v[172:175], v[76:79], v[4:7]
    ds_read_b64_tr_b16 v[148:149], v234 offset:45056
    v_mfma_f32_16x16x32_bf16 v[8:11], v[176:179], v[76:79], v[8:11]
    ds_read_b64_tr_b16 v[150:151], v234 offset:46080
    v_mfma_f32_16x16x32_bf16 v[12:15], v[180:183], v[76:79], v[12:15]
    ds_read_b64_tr_b16 v[152:153], v235 offset:45056
    v_mfma_f32_16x16x32_bf16 v[16:19], v[184:187], v[76:79], v[16:19]
    ds_read_b64_tr_b16 v[154:155], v235 offset:46080
    v_mfma_f32_16x16x32_bf16 v[20:23], v[172:175], v[80:83], v[20:23]
    ds_read_b64_tr_b16 v[156:157], v242 offset:0
    v_mfma_f32_16x16x32_bf16 v[24:27], v[176:179], v[80:83], v[24:27]
    ds_read_b64_tr_b16 v[158:159], v242 offset:1024
    v_mfma_f32_16x16x32_bf16 v[28:31], v[180:183], v[80:83], v[28:31]
    buffer_load_dwordx4 v[68:71], v226, s[40:43], s77 offen sc1
    v_mfma_f32_16x16x32_bf16 v[32:35], v[184:187], v[80:83], v[32:35]
    buffer_load_dwordx4 v[72:75], v227, s[40:43], s77 offen sc1
    s_waitcnt vmcnt(10)
    v_mfma_f32_16x16x32_bf16 v[4:7], v[188:191], v[84:87], v[4:7]
    ds_read_b64_tr_b16 v[160:161], v243 offset:0
    v_mfma_f32_16x16x32_bf16 v[8:11], v[192:195], v[84:87], v[8:11]
    ds_read_b64_tr_b16 v[162:163], v243 offset:1024
    v_mfma_f32_16x16x32_bf16 v[12:15], v[196:199], v[84:87], v[12:15]
    ds_read_b64_tr_b16 v[164:165], v244 offset:0
    v_mfma_f32_16x16x32_bf16 v[16:19], v[200:203], v[84:87], v[16:19]
    ds_read_b64_tr_b16 v[166:167], v244 offset:1024
    v_mfma_f32_16x16x32_bf16 v[20:23], v[188:191], v[88:91], v[20:23]
    ds_read_b64_tr_b16 v[168:169], v245 offset:0
    v_mfma_f32_16x16x32_bf16 v[24:27], v[192:195], v[88:91], v[24:27]
    ds_read_b64_tr_b16 v[170:171], v245 offset:1024
    v_mfma_f32_16x16x32_bf16 v[28:31], v[196:199], v[88:91], v[28:31]
    buffer_load_dwordx4 v[76:79], v224, s[40:43], s78 offen sc1
    v_mfma_f32_16x16x32_bf16 v[32:35], v[200:203], v[88:91], v[32:35]
    buffer_load_dwordx4 v[80:83], v225, s[40:43], s78 offen sc1
    s_waitcnt vmcnt(10)
    v_mfma_f32_16x16x32_bf16 v[4:7], v[204:207], v[36:39], v[4:7]
    ds_read_b64_tr_b16 v[172:173], v242 offset:4096
    v_mfma_f32_16x16x32_bf16 v[8:11], v[208:211], v[36:39], v[8:11]
    ds_read_b64_tr_b16 v[174:175], v242 offset:5120
    v_mfma_f32_16x16x32_bf16 v[12:15], v[212:215], v[36:39], v[12:15]
    ds_read_b64_tr_b16 v[176:177], v243 offset:4096
    v_mfma_f32_16x16x32_bf16 v[16:19], v[216:219], v[36:39], v[16:19]
    ds_read_b64_tr_b16 v[178:179], v243 offset:5120
    v_mfma_f32_16x16x32_bf16 v[20:23], v[204:207], v[40:43], v[20:23]
    ds_read_b64_tr_b16 v[180:181], v244 offset:4096
    v_mfma_f32_16x16x32_bf16 v[24:27], v[208:211], v[40:43], v[24:27]
    ds_read_b64_tr_b16 v[182:183], v244 offset:5120
    v_mfma_f32_16x16x32_bf16 v[28:31], v[212:215], v[40:43], v[28:31]
    buffer_load_dwordx4 v[84:87], v226, s[40:43], s78 offen sc1
    v_mfma_f32_16x16x32_bf16 v[32:35], v[216:219], v[40:43], v[32:35]
    buffer_load_dwordx4 v[88:91], v227, s[40:43], s78 offen sc1
    s_waitcnt vmcnt(10) lgkmcnt(6)
    v_mfma_f32_16x16x32_bf16 v[4:7], v[92:95], v[44:47], v[4:7]
    ds_read_b64_tr_b16 v[184:185], v245 offset:4096
    v_mfma_f32_16x16x32_bf16 v[8:11], v[96:99], v[44:47], v[8:11]
    ds_read_b64_tr_b16 v[186:187], v245 offset:5120
    v_mfma_f32_16x16x32_bf16 v[12:15], v[100:103], v[44:47], v[12:15]
    ds_read_b64_tr_b16 v[188:189], v242 offset:8192
    v_mfma_f32_16x16x32_bf16 v[16:19], v[104:107], v[44:47], v[16:19]
    ds_read_b64_tr_b16 v[190:191], v242 offset:9216
    v_mfma_f32_16x16x32_bf16 v[20:23], v[92:95], v[48:51], v[20:23]
    ds_read_b64_tr_b16 v[192:193], v243 offset:8192
    v_mfma_f32_16x16x32_bf16 v[24:27], v[96:99], v[48:51], v[24:27]
    ds_read_b64_tr_b16 v[194:195], v243 offset:9216
    v_mfma_f32_16x16x32_bf16 v[28:31], v[100:103], v[48:51], v[28:31]
    buffer_load_dwordx4 v[36:39], v224, s[40:43], s79 offen sc1
    v_mfma_f32_16x16x32_bf16 v[32:35], v[104:107], v[48:51], v[32:35]
    buffer_load_dwordx4 v[40:43], v225, s[40:43], s79 offen sc1
    s_waitcnt vmcnt(10) lgkmcnt(6)
    v_mfma_f32_16x16x32_bf16 v[4:7], v[108:111], v[52:55], v[4:7]
    ds_read_b64_tr_b16 v[196:197], v244 offset:8192
    v_mfma_f32_16x16x32_bf16 v[8:11], v[112:115], v[52:55], v[8:11]
    ds_read_b64_tr_b16 v[198:199], v244 offset:9216
    v_mfma_f32_16x16x32_bf16 v[12:15], v[116:119], v[52:55], v[12:15]
    ds_read_b64_tr_b16 v[200:201], v245 offset:8192
    v_mfma_f32_16x16x32_bf16 v[16:19], v[120:123], v[52:55], v[16:19]
    ds_read_b64_tr_b16 v[202:203], v245 offset:9216
    v_mfma_f32_16x16x32_bf16 v[20:23], v[108:111], v[56:59], v[20:23]
    ds_read_b64_tr_b16 v[204:205], v242 offset:12288
    v_mfma_f32_16x16x32_bf16 v[24:27], v[112:115], v[56:59], v[24:27]
    ds_read_b64_tr_b16 v[206:207], v242 offset:13312
    v_mfma_f32_16x16x32_bf16 v[28:31], v[116:119], v[56:59], v[28:31]
    buffer_load_dwordx4 v[44:47], v226, s[40:43], s79 offen sc1
    v_mfma_f32_16x16x32_bf16 v[32:35], v[120:123], v[56:59], v[32:35]
    buffer_load_dwordx4 v[48:51], v227, s[40:43], s79 offen sc1
    s_waitcnt vmcnt(10) lgkmcnt(6)
    v_mfma_f32_16x16x32_bf16 v[4:7], v[124:127], v[60:63], v[4:7]
    ds_read_b64_tr_b16 v[208:209], v243 offset:12288
    v_mfma_f32_16x16x32_bf16 v[8:11], v[128:131], v[60:63], v[8:11]
    ds_read_b64_tr_b16 v[210:211], v243 offset:13312
    v_mfma_f32_16x16x32_bf16 v[12:15], v[132:135], v[60:63], v[12:15]
    ds_read_b64_tr_b16 v[212:213], v244 offset:12288
    v_mfma_f32_16x16x32_bf16 v[16:19], v[136:139], v[60:63], v[16:19]
    ds_read_b64_tr_b16 v[214:215], v244 offset:13312
    v_mfma_f32_16x16x32_bf16 v[20:23], v[124:127], v[64:67], v[20:23]
    ds_read_b64_tr_b16 v[216:217], v245 offset:12288
    v_mfma_f32_16x16x32_bf16 v[24:27], v[128:131], v[64:67], v[24:27]
    ds_read_b64_tr_b16 v[218:219], v245 offset:13312
    v_mfma_f32_16x16x32_bf16 v[28:31], v[132:135], v[64:67], v[28:31]
    buffer_load_dwordx4 v[52:55], v224, s[40:43], s80 offen sc1
    v_mfma_f32_16x16x32_bf16 v[32:35], v[136:139], v[64:67], v[32:35]
    buffer_load_dwordx4 v[56:59], v225, s[40:43], s80 offen sc1
    s_waitcnt vmcnt(10) lgkmcnt(6)
    v_mfma_f32_16x16x32_bf16 v[4:7], v[140:143], v[68:71], v[4:7]
    ds_read_b64_tr_b16 v[92:93], v242 offset:16384
    v_mfma_f32_16x16x32_bf16 v[8:11], v[144:147], v[68:71], v[8:11]
    ds_read_b64_tr_b16 v[94:95], v242 offset:17408
    v_mfma_f32_16x16x32_bf16 v[12:15], v[148:151], v[68:71], v[12:15]
    ds_read_b64_tr_b16 v[96:97], v243 offset:16384
    v_mfma_f32_16x16x32_bf16 v[16:19], v[152:155], v[68:71], v[16:19]
    ds_read_b64_tr_b16 v[98:99], v243 offset:17408
    v_mfma_f32_16x16x32_bf16 v[20:23], v[140:143], v[72:75], v[20:23]
    ds_read_b64_tr_b16 v[100:101], v244 offset:16384
    v_mfma_f32_16x16x32_bf16 v[24:27], v[144:147], v[72:75], v[24:27]
    ds_read_b64_tr_b16 v[102:103], v244 offset:17408
    v_mfma_f32_16x16x32_bf16 v[28:31], v[148:151], v[72:75], v[28:31]
    buffer_load_dwordx4 v[60:63], v226, s[40:43], s80 offen sc1
    v_mfma_f32_16x16x32_bf16 v[32:35], v[152:155], v[72:75], v[32:35]
    buffer_load_dwordx4 v[64:67], v227, s[40:43], s80 offen sc1
    s_waitcnt vmcnt(10) lgkmcnt(6)
    v_mfma_f32_16x16x32_bf16 v[4:7], v[156:159], v[76:79], v[4:7]
    ds_read_b64_tr_b16 v[104:105], v245 offset:16384
    v_mfma_f32_16x16x32_bf16 v[8:11], v[160:163], v[76:79], v[8:11]
    ds_read_b64_tr_b16 v[106:107], v245 offset:17408
    v_mfma_f32_16x16x32_bf16 v[12:15], v[164:167], v[76:79], v[12:15]
    ds_read_b64_tr_b16 v[108:109], v242 offset:20480
    v_mfma_f32_16x16x32_bf16 v[16:19], v[168:171], v[76:79], v[16:19]
    ds_read_b64_tr_b16 v[110:111], v242 offset:21504
    v_mfma_f32_16x16x32_bf16 v[20:23], v[156:159], v[80:83], v[20:23]
    ds_read_b64_tr_b16 v[112:113], v243 offset:20480
    v_mfma_f32_16x16x32_bf16 v[24:27], v[160:163], v[80:83], v[24:27]
    ds_read_b64_tr_b16 v[114:115], v243 offset:21504
    v_mfma_f32_16x16x32_bf16 v[28:31], v[164:167], v[80:83], v[28:31]
    buffer_load_dwordx4 v[68:71], v224, s[40:43], s81 offen sc1
    v_mfma_f32_16x16x32_bf16 v[32:35], v[168:171], v[80:83], v[32:35]
    buffer_load_dwordx4 v[72:75], v225, s[40:43], s81 offen sc1
    s_waitcnt vmcnt(10) lgkmcnt(6)
    v_mfma_f32_16x16x32_bf16 v[4:7], v[172:175], v[84:87], v[4:7]
    ds_read_b64_tr_b16 v[116:117], v244 offset:20480
    v_mfma_f32_16x16x32_bf16 v[8:11], v[176:179], v[84:87], v[8:11]
    ds_read_b64_tr_b16 v[118:119], v244 offset:21504
    v_mfma_f32_16x16x32_bf16 v[12:15], v[180:183], v[84:87], v[12:15]
    ds_read_b64_tr_b16 v[120:121], v245 offset:20480
    v_mfma_f32_16x16x32_bf16 v[16:19], v[184:187], v[84:87], v[16:19]
    ds_read_b64_tr_b16 v[122:123], v245 offset:21504
    v_mfma_f32_16x16x32_bf16 v[20:23], v[172:175], v[88:91], v[20:23]
    ds_read_b64_tr_b16 v[124:125], v242 offset:24576
    v_mfma_f32_16x16x32_bf16 v[24:27], v[176:179], v[88:91], v[24:27]
    ds_read_b64_tr_b16 v[126:127], v242 offset:25600
    v_mfma_f32_16x16x32_bf16 v[28:31], v[180:183], v[88:91], v[28:31]
    buffer_load_dwordx4 v[76:79], v226, s[40:43], s81 offen sc1
    v_mfma_f32_16x16x32_bf16 v[32:35], v[184:187], v[88:91], v[32:35]
    buffer_load_dwordx4 v[80:83], v227, s[40:43], s81 offen sc1
    s_waitcnt vmcnt(10) lgkmcnt(6)
    v_mfma_f32_16x16x32_bf16 v[4:7], v[188:191], v[36:39], v[4:7]
    ds_read_b64_tr_b16 v[128:129], v243 offset:24576
    v_mfma_f32_16x16x32_bf16 v[8:11], v[192:195], v[36:39], v[8:11]
    ds_read_b64_tr_b16 v[130:131], v243 offset:25600
    v_mfma_f32_16x16x32_bf16 v[12:15], v[196:199], v[36:39], v[12:15]
    ds_read_b64_tr_b16 v[132:133], v244 offset:24576
    v_mfma_f32_16x16x32_bf16 v[16:19], v[200:203], v[36:39], v[16:19]
    ds_read_b64_tr_b16 v[134:135], v244 offset:25600
    v_mfma_f32_16x16x32_bf16 v[20:23], v[188:191], v[40:43], v[20:23]
    ds_read_b64_tr_b16 v[136:137], v245 offset:24576
    v_mfma_f32_16x16x32_bf16 v[24:27], v[192:195], v[40:43], v[24:27]
    ds_read_b64_tr_b16 v[138:139], v245 offset:25600
    v_mfma_f32_16x16x32_bf16 v[28:31], v[196:199], v[40:43], v[28:31]
    v_mfma_f32_16x16x32_bf16 v[32:35], v[200:203], v[40:43], v[32:35]
    s_waitcnt vmcnt(8) lgkmcnt(6)
    v_mfma_f32_16x16x32_bf16 v[4:7], v[204:207], v[44:47], v[4:7]
    ds_read_b64_tr_b16 v[140:141], v242 offset:28672
    v_mfma_f32_16x16x32_bf16 v[8:11], v[208:211], v[44:47], v[8:11]
    ds_read_b64_tr_b16 v[142:143], v242 offset:29696
    v_mfma_f32_16x16x32_bf16 v[12:15], v[212:215], v[44:47], v[12:15]
    ds_read_b64_tr_b16 v[144:145], v243 offset:28672
    v_mfma_f32_16x16x32_bf16 v[16:19], v[216:219], v[44:47], v[16:19]
    ds_read_b64_tr_b16 v[146:147], v243 offset:29696
    v_mfma_f32_16x16x32_bf16 v[20:23], v[204:207], v[48:51], v[20:23]
    ds_read_b64_tr_b16 v[148:149], v244 offset:28672
    v_mfma_f32_16x16x32_bf16 v[24:27], v[208:211], v[48:51], v[24:27]
    ds_read_b64_tr_b16 v[150:151], v244 offset:29696
    v_mfma_f32_16x16x32_bf16 v[28:31], v[212:215], v[48:51], v[28:31]
    v_mfma_f32_16x16x32_bf16 v[32:35], v[216:219], v[48:51], v[32:35]
    ds_read_b32 v2, v3
    s_waitcnt vmcnt(6) lgkmcnt(6)
    v_mfma_f32_16x16x32_bf16 v[4:7], v[92:95], v[52:55], v[4:7]
    ds_read_b64_tr_b16 v[152:153], v245 offset:28672
    v_mfma_f32_16x16x32_bf16 v[8:11], v[96:99], v[52:55], v[8:11]
    ds_read_b64_tr_b16 v[154:155], v245 offset:29696
    v_mfma_f32_16x16x32_bf16 v[12:15], v[100:103], v[52:55], v[12:15]
    v_mfma_f32_16x16x32_bf16 v[16:19], v[104:107], v[52:55], v[16:19]
    v_mfma_f32_16x16x32_bf16 v[20:23], v[92:95], v[56:59], v[20:23]
    v_mfma_f32_16x16x32_bf16 v[24:27], v[96:99], v[56:59], v[24:27]
    v_mfma_f32_16x16x32_bf16 v[28:31], v[100:103], v[56:59], v[28:31]
    v_mfma_f32_16x16x32_bf16 v[32:35], v[104:107], v[56:59], v[32:35]
    s_waitcnt vmcnt(4) lgkmcnt(2)
    v_cmp_eq_u32 vcc, 0, v2
    v_mfma_f32_16x16x32_bf16 v[4:7], v[108:111], v[60:63], v[4:7]
    v_mfma_f32_16x16x32_bf16 v[8:11], v[112:115], v[60:63], v[8:11]
    s_cbranch_vccnz L_gf
L_gf_ret:
    v_mfma_f32_16x16x32_bf16 v[12:15], v[116:119], v[60:63], v[12:15]
    ds_read_b128 v[156:159], v238 offset:0
    v_mfma_f32_16x16x32_bf16 v[16:19], v[120:123], v[60:63], v[16:19]
    ds_read_b128 v[160:163], v238 offset:1024
    v_mfma_f32_16x16x32_bf16 v[20:23], v[108:111], v[64:67], v[20:23]
    ds_read_b128 v[164:167], v238 offset:2048
    v_mfma_f32_16x16x32_bf16 v[24:27], v[112:115], v[64:67], v[24:27]
    ds_read_b128 v[168:171], v238 offset:3072
    v_mfma_f32_16x16x32_bf16 v[28:31], v[116:119], v[64:67], v[28:31]
    v_mfma_f32_16x16x32_bf16 v[32:35], v[120:123], v[64:67], v[32:35]
    s_waitcnt vmcnt(2) lgkmcnt(4)
    v_mfma_f32_16x16x32_bf16 v[4:7], v[124:127], v[68:71], v[4:7]
    ds_read_b128 v[172:175], v238 offset:4096
    v_mfma_f32_16x16x32_bf16 v[8:11], v[128:131], v[68:71], v[8:11]
    ds_read_b128 v[176:179], v238 offset:5120
    v_mfma_f32_16x16x32_bf16 v[12:15], v[132:135], v[68:71], v[12:15]
    ds_read_b128 v[180:183], v238 offset:6144
    v_mfma_f32_16x16x32_bf16 v[16:19], v[136:139], v[68:71], v[16:19]
    ds_read_b128 v[184:187], v238 offset:7168
    v_mfma_f32_16x16x32_bf16 v[20:23], v[124:127], v[72:75], v[20:23]
    ds_read_b64 v[240:241], v238 offset:8192
    v_mfma_f32_16x16x32_bf16 v[24:27], v[128:131], v[72:75], v[24:27]
    v_mfma_f32_16x16x32_bf16 v[28:31], v[132:135], v[72:75], v[28:31]
    v_cmp_gt_u32_e64 vcc, 3, v2
    v_mfma_f32_16x16x32_bf16 v[32:35], v[136:139], v[72:75], v[32:35]
    s_waitcnt vmcnt(0) lgkmcnt(5)
    s_cbranch_vccnz L_yd
    v_mfma_f32_16x16x32_bf16 v[4:7], v[140:143], v[76:79], v[4:7]
    v_mfma_f32_16x16x32_bf16 v[8:11], v[144:147], v[76:79], v[8:11]
    v_mfma_f32_16x16x32_bf16 v[12:15], v[148:151], v[76:79], v[12:15]
    v_mfma_f32_16x16x32_bf16 v[16:19], v[152:155], v[76:79], v[16:19]
    v_mfma_f32_16x16x32_bf16 v[20:23], v[140:143], v[80:83], v[20:23]
    v_mfma_f32_16x16x32_bf16 v[24:27], v[144:147], v[80:83], v[24:27]
    v_mfma_f32_16x16x32_bf16 v[28:31], v[148:151], v[80:83], v[28:31]
    v_mfma_f32_16x16x32_bf16 v[32:35], v[152:155], v[80:83], v[32:35]
    s_waitcnt lgkmcnt(0)
L_ydret:
    s_nop 0
    v_pk_fma_f32 v[156:157], v[4:5], v[240:241], v[156:157] op_sel_hi:[1,0,1]
    v_pk_fma_f32 v[158:159], v[6:7], v[240:241], v[158:159] op_sel_hi:[1,0,1]
    v_cvt_pk_bf16_f32 v156, v156, v157
    v_cvt_pk_bf16_f32 v157, v158, v159
    ds_write_b64 v236, v[156:157] offset:0
    v_pk_fma_f32 v[160:161], v[8:9], v[240:241], v[160:161] op_sel_hi:[1,0,1]
    v_pk_fma_f32 v[162:163], v[10:11], v[240:241], v[162:163] op_sel_hi:[1,0,1]
    v_cvt_pk_bf16_f32 v160, v160, v161
    v_cvt_pk_bf16_f32 v161, v162, v163
    ds_write_b64 v236, v[160:161] offset:32
    v_pk_fma_f32 v[164:165], v[12:13], v[240:241], v[164:165] op_sel_hi:[1,0,1]
    v_pk_fma_f32 v[166:167], v[14:15], v[240:241], v[166:167] op_sel_hi:[1,0,1]
    v_cvt_pk_bf16_f32 v164, v164, v165
    v_cvt_pk_bf16_f32 v165, v166, v167
    ds_write_b64 v236, v[164:165] offset:64
    v_pk_fma_f32 v[168:169], v[16:17], v[240:241], v[168:169] op_sel_hi:[1,0,1]
    v_pk_fma_f32 v[170:171], v[18:19], v[240:241], v[170:171] op_sel_hi:[1,0,1]
    v_cvt_pk_bf16_f32 v168, v168, v169
    v_cvt_pk_bf16_f32 v169, v170, v171
    ds_write_b64 v236, v[168:169] offset:96
    ds_read_b128 v[52:55], v237 offset:0
    ds_read_b128 v[56:59], v237 offset:1152
    v_pk_fma_f32 v[172:173], v[20:21], v[240:241], v[172:173] op_sel:[0,1,0] op_sel_hi:[1,1,1]
    v_pk_fma_f32 v[174:175], v[22:23], v[240:241], v[174:175] op_sel:[0,1,0] op_sel_hi:[1,1,1]
    v_cvt_pk_bf16_f32 v172, v172, v173
    v_cvt_pk_bf16_f32 v173, v174, v175
    ds_write_b64 v236, v[172:173] offset:2304
    v_pk_fma_f32 v[176:177], v[24:25], v[240:241], v[176:177] op_sel:[0,1,0] op_sel_hi:[1,1,1]
    v_pk_fma_f32 v[178:179], v[26:27], v[240:241], v[178:179] op_sel:[0,1,0] op_sel_hi:[1,1,1]
    v_cvt_pk_bf16_f32 v176, v176, v177
    v_cvt_pk_bf16_f32 v177, v178, v179
    ds_write_b64 v236, v[176:177] offset:2336
    v_pk_fma_f32 v[180:181], v[28:29], v[240:241], v[180:181] op_sel:[0,1,0] op_sel_hi:[1,1,1]
    v_pk_fma_f32 v[182:183], v[30:31], v[240:241], v[182:183] op_sel:[0,1,0] op_sel_hi:[1,1,1]
    v_cvt_pk_bf16_f32 v180, v180, v181
    v_cvt_pk_bf16_f32 v181, v182, v183
    ds_write_b64 v236, v[180:181] offset:2368
    v_pk_fma_f32 v[184:185], v[32:33], v[240:241], v[184:185] op_sel:[0,1,0] op_sel_hi:[1,1,1]
    v_pk_fma_f32 v[186:187], v[34:35], v[240:241], v[186:187] op_sel:[0,1,0] op_sel_hi:[1,1,1]
    v_cvt_pk_bf16_f32 v184, v184, v185
    v_cvt_pk_bf16_f32 v185, v186, v187
    ds_write_b64 v236, v[184:185] offset:2400
    ds_read_b128 v[60:63], v237 offset:2304
    ds_read_b128 v[64:67], v237 offset:3456
    s_waitcnt lgkmcnt(7)
    buffer_store_dwordx4 v[52:55], v229, s[48:51], 0 offen
    s_waitcnt lgkmcnt(6)
    buffer_store_dwordx4 v[56:59], v230, s[48:51], 0 offen
    s_waitcnt lgkmcnt(1)
    buffer_store_dwordx4 v[60:63], v231, s[48:51], 0 offen
    s_waitcnt lgkmcnt(0)
    buffer_store_dwordx4 v[64:67], v250, s[48:51], 0 offen
    s_endpgm
    s_nop 0
L_ookb:
    buffer_load_dwordx4 v[52:55], v224, s[40:43], s73 offen sc1
    buffer_load_dwordx4 v[60:63], v226, s[40:43], s73 offen sc1
    ds_read_b64_tr_b16 v[92:93], v232 offset:32768
    ds_read_b64_tr_b16 v[94:95], v232 offset:33792
    ds_read_b64_tr_b16 v[96:97], v233 offset:32768
    ds_read_b64_tr_b16 v[98:99], v233 offset:33792
    ds_read_b64_tr_b16 v[100:101], v234 offset:32768
    ds_read_b64_tr_b16 v[102:103], v234 offset:33792
    ds_read_b64_tr_b16 v[104:105], v235 offset:32768
    ds_read_b64_tr_b16 v[106:107], v235 offset:33792
    ds_read_b64_tr_b16 v[108:109], v232 offset:36864
    ds_read_b64_tr_b16 v[110:111], v232 offset:37888
    ds_read_b64_tr_b16 v[112:113], v233 offset:36864
    ds_read_b64_tr_b16 v[114:115], v233 offset:37888
    ds_read_b64_tr_b16 v[116:117], v234 offset:36864
    ds_read_b64_tr_b16 v[118:119], v234 offset:37888
    ds_read_b64_tr_b16 v[120:121], v235 offset:36864
    ds_read_b64_tr_b16 v[122:123], v235 offset:37888
    buffer_load_dwordx4 v[68:71], v224, s[40:43], s74 offen sc1
    buffer_load_dwordx4 v[76:79], v226, s[40:43], s74 offen sc1
    buffer_load_dwordx4 v[84:87], v224, s[40:43], s75 offen sc1
    buffer_load_dwordx4 v[36:39], v226, s[40:43], s75 offen sc1
    s_waitcnt lgkmcnt(15)
    s_load_dword s21, s[40:41], s20 glc
    s_waitcnt vmcnt(5)
    v_mfma_f32_16x16x32_bf16 v[4:7], v[124:127], v[52:55], v[4:7]
    v_mfma_f32_16x16x32_bf16 v[8:11], v[128:131], v[52:55], v[8:11]
    v_mfma_f32_16x16x32_bf16 v[12:15], v[132:135], v[52:55], v[12:15]
    v_mfma_f32_16x16x32_bf16 v[16:19], v[136:139], v[52:55], v[16:19]
    s_load_dword s21, s[40:41], s20 glc
    buffer_load_dwordx4 v[44:47], v224, s[40:43], s76 offen sc1
    s_waitcnt vmcnt(5)
    v_mfma_f32_16x16x32_bf16 v[4:7], v[140:143], v[60:63], v[4:7]
    ds_read_b64_tr_b16 v[124:125], v232 offset:40960
    ds_read_b64_tr_b16 v[126:127], v232 offset:41984
    v_mfma_f32_16x16x32_bf16 v[8:11], v[144:147], v[60:63], v[8:11]
    ds_read_b64_tr_b16 v[128:129], v233 offset:40960
    ds_read_b64_tr_b16 v[130:131], v233 offset:41984
    v_mfma_f32_16x16x32_bf16 v[12:15], v[148:151], v[60:63], v[12:15]
    ds_read_b64_tr_b16 v[132:133], v234 offset:40960
    ds_read_b64_tr_b16 v[134:135], v234 offset:41984
    v_mfma_f32_16x16x32_bf16 v[16:19], v[152:155], v[60:63], v[16:19]
    buffer_load_dwordx4 v[52:55], v226, s[40:43], s76 offen sc1
    s_waitcnt vmcnt(5)
    v_mfma_f32_16x16x32_bf16 v[4:7], v[156:159], v[68:71], v[4:7]
    ds_read_b64_tr_b16 v[136:137], v235 offset:40960
    ds_read_b64_tr_b16 v[138:139], v235 offset:41984
    v_mfma_f32_16x16x32_bf16 v[8:11], v[160:163], v[68:71], v[8:11]
    ds_read_b64_tr_b16 v[140:141], v232 offset:45056
    ds_read_b64_tr_b16 v[142:143], v232 offset:46080
    v_mfma_f32_16x16x32_bf16 v[12:15], v[164:167], v[68:71], v[12:15]
    ds_read_b64_tr_b16 v[144:145], v233 offset:45056
    ds_read_b64_tr_b16 v[146:147], v233 offset:46080
    v_mfma_f32_16x16x32_bf16 v[16:19], v[168:171], v[68:71], v[16:19]
    s_cmp_ge_u32 s21, 5
    s_cbranch_scc0 L_mb0b
L_mb_retb:
    buffer_load_dwordx4 v[60:63], v224, s[40:43], s77 offen sc1
    s_waitcnt vmcnt(5)
    v_mfma_f32_16x16x32_bf16 v[4:7], v[172:175], v[76:79], v[4:7]
    ds_read_b64_tr_b16 v[148:149], v234 offset:45056
    ds_read_b64_tr_b16 v[150:151], v234 offset:46080
    v_mfma_f32_16x16x32_bf16 v[8:11], v[176:179], v[76:79], v[8:11]
    ds_read_b64_tr_b16 v[152:153], v235 offset:45056
    ds_read_b64_tr_b16 v[154:155], v235 offset:46080
    v_mfma_f32_16x16x32_bf16 v[12:15], v[180:183], v[76:79], v[12:15]
    ds_read_b64_tr_b16 v[156:157], v242 offset:0
    ds_read_b64_tr_b16 v[158:159], v242 offset:1024
    v_mfma_f32_16x16x32_bf16 v[16:19], v[184:187], v[76:79], v[16:19]
    buffer_load_dwordx4 v[68:71], v226, s[40:43], s77 offen sc1
    s_waitcnt vmcnt(5)
    v_mfma_f32_16x16x32_bf16 v[4:7], v[188:191], v[84:87], v[4:7]
    ds_read_b64_tr_b16 v[160:161], v243 offset:0
    ds_read_b64_tr_b16 v[162:163], v243 offset:1024
    v_mfma_f32_16x16x32_bf16 v[8:11], v[192:195], v[84:87], v[8:11]
    ds_read_b64_tr_b16 v[164:165], v244 offset:0
    ds_read_b64_tr_b16 v[166:167], v244 offset:1024
    v_mfma_f32_16x16x32_bf16 v[12:15], v[196:199], v[84:87], v[12:15]
    ds_read_b64_tr_b16 v[168:169], v245 offset:0
    ds_read_b64_tr_b16 v[170:171], v245 offset:1024
    v_mfma_f32_16x16x32_bf16 v[16:19], v[200:203], v[84:87], v[16:19]
    buffer_load_dwordx4 v[76:79], v224, s[40:43], s78 offen sc1
    s_waitcnt vmcnt(5)
    v_mfma_f32_16x16x32_bf16 v[4:7], v[204:207], v[36:39], v[4:7]
    ds_read_b64_tr_b16 v[172:173], v242 offset:4096
    ds_read_b64_tr_b16 v[174:175], v242 offset:5120
    v_mfma_f32_16x16x32_bf16 v[8:11], v[208:211], v[36:39], v[8:11]
    ds_read_b64_tr_b16 v[176:177], v243 offset:4096
    ds_read_b64_tr_b16 v[178:179], v243 offset:5120
    v_mfma_f32_16x16x32_bf16 v[12:15], v[212:215], v[36:39], v[12:15]
    ds_read_b64_tr_b16 v[180:181], v244 offset:4096
    ds_read_b64_tr_b16 v[182:183], v244 offset:5120
    v_mfma_f32_16x16x32_bf16 v[16:19], v[216:219], v[36:39], v[16:19]
    buffer_load_dwordx4 v[84:87], v226, s[40:43], s78 offen sc1
    s_waitcnt vmcnt(5) lgkmcnt(6)
    v_mfma_f32_16x16x32_bf16 v[4:7], v[92:95], v[44:47], v[4:7]
    ds_read_b64_tr_b16 v[184:185], v245 offset:4096
    ds_read_b64_tr_b16 v[186:187], v245 offset:5120
    v_mfma_f32_16x16x32_bf16 v[8:11], v[96:99], v[44:47], v[8:11]
    ds_read_b64_tr_b16 v[188:189], v242 offset:8192
    ds_read_b64_tr_b16 v[190:191], v242 offset:9216
    v_mfma_f32_16x16x32_bf16 v[12:15], v[100:103], v[44:47], v[12:15]
    ds_read_b64_tr_b16 v[192:193], v243 offset:8192
    ds_read_b64_tr_b16 v[194:195], v243 offset:9216
    v_mfma_f32_16x16x32_bf16 v[16:19], v[104:107], v[44:47], v[16:19]
    buffer_load_dwordx4 v[36:39], v224, s[40:43], s79 offen sc1
    s_waitcnt vmcnt(5) lgkmcnt(6)
    v_mfma_f32_16x16x32_bf16 v[4:7], v[108:111], v[52:55], v[4:7]
    ds_read_b64_tr_b16 v[196:197], v244 offset:8192
    ds_read_b64_tr_b16 v[198:199], v244 offset:9216
    v_mfma_f32_16x16x32_bf16 v[8:11], v[112:115], v[52:55], v[8:11]
    ds_read_b64_tr_b16 v[200:201], v245 offset:8192
    ds_read_b64_tr_b16 v[202:203], v245 offset:9216
    v_mfma_f32_16x16x32_bf16 v[12:15], v[116:119], v[52:55], v[12:15]
    ds_read_b64_tr_b16 v[204:205], v242 offset:12288
    ds_read_b64_tr_b16 v[206:207], v242 offset:13312
    v_mfma_f32_16x16x32_bf16 v[16:19], v[120:123], v[52:55], v[16:19]
    buffer_load_dwordx4 v[44:47], v226, s[40:43], s79 offen sc1
    s_waitcnt vmcnt(5) lgkmcnt(6)
    v_mfma_f32_16x16x32_bf16 v[4:7], v[124:127], v[60:63], v[4:7]
    ds_read_b64_tr_b16 v[208:209], v243 offset:12288
    ds_read_b64_tr_b16 v[210:211], v243 offset:13312
    v_mfma_f32_16x16x32_bf16 v[8:11], v[128:131], v[60:63], v[8:11]
    ds_read_b64_tr_b16 v[212:213], v244 offset:12288
    ds_read_b64_tr_b16 v[214:215], v244 offset:13312
    v_mfma_f32_16x16x32_bf16 v[12:15], v[132:135], v[60:63], v[12:15]
    ds_read_b64_tr_b16 v[216:217], v245 offset:12288
    ds_read_b64_tr_b16 v[218:219], v245 offset:13312
    v_mfma_f32_16x16x32_bf16 v[16:19], v[136:139], v[60:63], v[16:19]
    buffer_load_dwordx4 v[52:55], v224, s[40:43], s80 offen sc1
    s_waitcnt vmcnt(5) lgkmcnt(6)
    v_mfma_f32_16x16x32_bf16 v[4:7], v[140:143], v[68:71], v[4:7]
    ds_read_b64_tr_b16 v[92:93], v242 offset:16384
    ds_read_b64_tr_b16 v[94:95], v242 offset:17408
    v_mfma_f32_16x16x32_bf16 v[8:11], v[144:147], v[68:71], v[8:11]
    ds_read_b64_tr_b16 v[96:97], v243 offset:16384
    ds_read_b64_tr_b16 v[98:99], v243 offset:17408
    v_mfma_f32_16x16x32_bf16 v[12:15], v[148:151], v[68:71], v[12:15]
    ds_read_b64_tr_b16 v[100:101], v244 offset:16384
    ds_read_b64_tr_b16 v[102:103], v244 offset:17408
    v_mfma_f32_16x16x32_bf16 v[16:19], v[152:155], v[68:71], v[16:19]
    buffer_load_dwordx4 v[60:63], v226, s[40:43], s80 offen sc1
    s_waitcnt vmcnt(5) lgkmcnt(6)
    v_mfma_f32_16x16x32_bf16 v[4:7], v[156:159], v[76:79], v[4:7]
    ds_read_b64_tr_b16 v[104:105], v245 offset:16384
    ds_read_b64_tr_b16 v[106:107], v245 offset:17408
    v_mfma_f32_16x16x32_bf16 v[8:11], v[160:163], v[76:79], v[8:11]
    ds_read_b64_tr_b16 v[108:109], v242 offset:20480
    ds_read_b64_tr_b16 v[110:111], v242 offset:21504
    v_mfma_f32_16x16x32_bf16 v[12:15], v[164:167], v[76:79], v[12:15]
    ds_read_b64_tr_b16 v[112:113], v243 offset:20480
    ds_read_b64_tr_b16 v[114:115], v243 offset:21504
    v_mfma_f32_16x16x32_bf16 v[16:19], v[168:171], v[76:79], v[16:19]
    buffer_load_dwordx4 v[68:71], v224, s[40:43], s81 offen sc1
    s_waitcnt vmcnt(5) lgkmcnt(6)
    v_mfma_f32_16x16x32_bf16 v[4:7], v[172:175], v[84:87], v[4:7]
L_pg4:
    s_cbranch_execz L_hopret
    ds_read_b64_tr_b16 v[116:117], v244 offset:20480
    ds_read_b64_tr_b16 v[118:119], v244 offset:21504
    v_mfma_f32_16x16x32_bf16 v[8:11], v[176:179], v[84:87], v[8:11]
    ds_read_b64_tr_b16 v[120:121], v245 offset:20480
    ds_read_b64_tr_b16 v[122:123], v245 offset:21504
    v_mfma_f32_16x16x32_bf16 v[12:15], v[180:183], v[84:87], v[12:15]
    ds_read_b64_tr_b16 v[124:125], v242 offset:24576
    ds_read_b64_tr_b16 v[126:127], v242 offset:25600
    v_mfma_f32_16x16x32_bf16 v[16:19], v[184:187], v[84:87], v[16:19]
    buffer_load_dwordx4 v[76:79], v226, s[40:43], s81 offen sc1
    s_waitcnt vmcnt(5) lgkmcnt(6)
    v_mfma_f32_16x16x32_bf16 v[4:7], v[188:191], v[36:39], v[4:7]
    ds_read_b64_tr_b16 v[128:129], v243 offset:24576
    ds_read_b64_tr_b16 v[130:131], v243 offset:25600
    v_mfma_f32_16x16x32_bf16 v[8:11], v[192:195], v[36:39], v[8:11]
    ds_read_b64_tr_b16 v[132:133], v244 offset:24576
    ds_read_b64_tr_b16 v[134:135], v244 offset:25600
    v_mfma_f32_16x16x32_bf16 v[12:15], v[196:199], v[36:39], v[12:15]
    ds_read_b64_tr_b16 v[136:137], v245 offset:24576
    ds_read_b64_tr_b16 v[138:139], v245 offset:25600
    v_mfma_f32_16x16x32_bf16 v[16:19], v[200:203], v[36:39], v[16:19]
    s_waitcnt vmcnt(4) lgkmcnt(6)
    v_mfma_f32_16x16x32_bf16 v[4:7], v[204:207], v[44:47], v[4:7]
    ds_read_b64_tr_b16 v[140:141], v242 offset:28672
    ds_read_b64_tr_b16 v[142:143], v242 offset:29696
    v_mfma_f32_16x16x32_bf16 v[8:11], v[208:211], v[44:47], v[8:11]
    ds_read_b64_tr_b16 v[144:145], v243 offset:28672
    ds_read_b64_tr_b16 v[146:147], v243 offset:29696
    v_mfma_f32_16x16x32_bf16 v[12:15], v[212:215], v[44:47], v[12:15]
    ds_read_b64_tr_b16 v[148:149], v244 offset:28672
    ds_read_b64_tr_b16 v[150:151], v244 offset:29696
    v_mfma_f32_16x16x32_bf16 v[16:19], v[216:219], v[44:47], v[16:19]
    ds_read_b32 v2, v3
    s_waitcnt vmcnt(3) lgkmcnt(6)
    v_mfma_f32_16x16x32_bf16 v[4:7], v[92:95], v[52:55], v[4:7]
    ds_read_b64_tr_b16 v[152:153], v245 offset:28672
    ds_read_b64_tr_b16 v[154:155], v245 offset:29696
    v_mfma_f32_16x16x32_bf16 v[8:11], v[96:99], v[52:55], v[8:11]
    v_mfma_f32_16x16x32_bf16 v[12:15], v[100:103], v[52:55], v[12:15]
    v_mfma_f32_16x16x32_bf16 v[16:19], v[104:107], v[52:55], v[16:19]
    s_waitcnt vmcnt(2) lgkmcnt(2)
    v_cmp_eq_u32_e64 vcc, 0, v2
    v_mfma_f32_16x16x32_bf16 v[4:7], v[108:111], v[60:63], v[4:7]
    s_cbranch_vccnz L_gfb
L_gf_retb:
    v_mfma_f32_16x16x32_bf16 v[8:11], v[112:115], v[60:63], v[8:11]
    ds_read_b128 v[156:159], v238 offset:0
    ds_read_b128 v[160:163], v238 offset:1024
    v_mfma_f32_16x16x32_bf16 v[12:15], v[116:119], v[60:63], v[12:15]
    ds_read_b128 v[164:167], v238 offset:2048
    ds_read_b128 v[168:171], v238 offset:3072
    v_mfma_f32_16x16x32_bf16 v[16:19], v[120:123], v[60:63], v[16:19]
    s_waitcnt vmcnt(1) lgkmcnt(4)
    v_mfma_f32_16x16x32_bf16 v[4:7], v[124:127], v[68:71], v[4:7]
    ds_read_b64 v[240:241], v238 offset:8192
    v_mfma_f32_16x16x32_bf16 v[8:11], v[128:131], v[68:71], v[8:11]
    v_mfma_f32_16x16x32_bf16 v[12:15], v[132:135], v[68:71], v[12:15]
    v_mfma_f32_16x16x32_bf16 v[16:19], v[136:139], v[68:71], v[16:19]
    v_cmp_gt_u32_e64 vcc, 2, v2
    s_waitcnt vmcnt(0) lgkmcnt(1)
    s_cbranch_vccnz L_ydb
    v_mfma_f32_16x16x32_bf16 v[4:7], v[140:143], v[76:79], v[4:7]
    v_mfma_f32_16x16x32_bf16 v[8:11], v[144:147], v[76:79], v[8:11]
    v_mfma_f32_16x16x32_bf16 v[12:15], v[148:151], v[76:79], v[12:15]
    v_mfma_f32_16x16x32_bf16 v[16:19], v[152:155], v[76:79], v[16:19]
    s_waitcnt lgkmcnt(0)
L_ydretb:
    s_nop 3
    v_pk_fma_f32 v[156:157], v[4:5], v[240:241], v[156:157] op_sel_hi:[1,0,1]
    v_pk_fma_f32 v[158:159], v[6:7], v[240:241], v[158:159] op_sel_hi:[1,0,1]
    v_cvt_pk_bf16_f32 v156, v156, v157
    v_cvt_pk_bf16_f32 v157, v158, v159
    ds_write_b64 v236, v[156:157] offset:0
    v_pk_fma_f32 v[160:161], v[8:9], v[240:241], v[160:161] op_sel_hi:[1,0,1]
    v_pk_fma_f32 v[162:163], v[10:11], v[240:241], v[162:163] op_sel_hi:[1,0,1]
    v_cvt_pk_bf16_f32 v160, v160, v161
    v_cvt_pk_bf16_f32 v161, v162, v163
    ds_write_b64 v236, v[160:161] offset:32
    v_pk_fma_f32 v[164:165], v[12:13], v[240:241], v[164:165] op_sel_hi:[1,0,1]
    v_pk_fma_f32 v[166:167], v[14:15], v[240:241], v[166:167] op_sel_hi:[1,0,1]
    v_cvt_pk_bf16_f32 v164, v164, v165
    v_cvt_pk_bf16_f32 v165, v166, v167
    ds_write_b64 v236, v[164:165] offset:64
    v_pk_fma_f32 v[168:169], v[16:17], v[240:241], v[168:169] op_sel_hi:[1,0,1]
    v_pk_fma_f32 v[170:171], v[18:19], v[240:241], v[170:171] op_sel_hi:[1,0,1]
    v_cvt_pk_bf16_f32 v168, v168, v169
    v_cvt_pk_bf16_f32 v169, v170, v171
    ds_write_b64 v236, v[168:169] offset:96
    ds_read_b128 v[52:55], v237 offset:0
    ds_read_b128 v[56:59], v237 offset:1152
    s_waitcnt lgkmcnt(1)
    buffer_store_dwordx4 v[52:55], v229, s[48:51], 0 offen
    s_waitcnt lgkmcnt(0)
    buffer_store_dwordx4 v[56:59], v230, s[48:51], 0 offen
    s_endpgm
L_lpost:
    s_lshl_b32 s63, s64, 30
    s_and_b32 s63, s63, 0x80000000
    s_sub_u32 s68, s56, 4
    v_bfe_u32 v8, v0, 3, 2
    v_add_u32 v8, s68, v8
    v_and_b32 v8, 0x80000000, v8
    v_xor_b32_e64 v8, s63, v8
    v_lshl_or_b32 v45, v0, 4, v8
    v_mov_b32 v46, 159744
    s_mul_i32 s20, s59, 1136
    s_add_u32 s20, s20, s58
    s_lshl_b32 s20, s20, 8
    s_add_u32 s20, s20, 286720
    s_lshr_b32 s70, s64, 1
    s_mul_i32 s68, s70, 3
    s_and_b32 s61, s52, 1
    s_mul_i32 s61, s61, 1536
    s_mul_i32 s63, s68, 7168
    s_lshl1_add_u32 s63, s61, s63
    s_add_u32 s63, s63, 131080
    v_lshlrev_b32 v255, 4, v0
    v_lshrrev_b32 v8, 2, v0
    v_bfi_b32 v8, v0, 0, v8
    v_and_b32 v8, 8, v8
    v_sub_u32 v8, v255, v8
    v_add_u32 v254, s63, v8
    s_mul_i32 s63, s68, 5
    s_sub_u32 s63, s63, s56
    s_add_u32 s63, s63, 4
    s_add_u32 s61, s61, 38912
    v_and_b32_e64 v9, 15, v0
    v_lshl_add_u32 v10, v9, 3, s61
    v_lshrrev_b32 v11, 4, v0
    v_add_u32 v8, s63, v11
    v_lshl_add_u32 v251, v8, 7, v10
    v_lshrrev_b32_e64 v8, 2, v8
    v_mul_u32_u24 v8, 6656, v8
    v_add_u32_e64 v251, v251, v8
    s_add_u32 s63, s63, 4
    s_lshr_b32 s62, s63, 2
    s_mul_i32 s62, s62, 6656
    s_lshl_b32 s63, s63, 7
    s_add_u32 s63, s63, s62
    v_add_u32 v252, s63, v10
    v_lshlrev_b32 v8, 2, v11
    v_sub_u32_e64 v9, v9, v8
    v_mov_b32 v11, 0xf149f2ca
    v_subrev_u32 v10, 0, v9
    v_and_b32 v10, 8, v10
    v_cmp_eq_u32 vcc, 0, v10
    s_nop 1
    v_cndmask_b32_e64 v240, v11, v10, vcc
    v_subrev_u32 v10, 1, v9
    v_and_b32 v10, 8, v10
    v_cmp_eq_u32 vcc, 0, v10
    s_nop 1
    v_cndmask_b32_e64 v241, v11, v10, vcc
    v_subrev_u32 v10, 2, v9
    v_and_b32 v10, 8, v10
    v_cmp_eq_u32 vcc, 0, v10
    s_nop 1
    v_cndmask_b32_e64 v242, v11, v10, vcc
    v_subrev_u32 v10, 3, v9
    v_and_b32 v10, 8, v10
    v_cmp_eq_u32 vcc, 0, v10
    s_nop 1
    v_cndmask_b32_e64 v243, v11, v10, vcc
    s_cmp_lt_i32 s60, 0
    s_cselect_b32 s63, 32, 0
    s_bitcmp1_b32 s52, 0
    s_cselect_b32 s63, 0, s63
    v_cmp_gt_u32 vcc, s63, v0
    s_nop 1
    v_cndmask_b32_e64 v244, v240, v11, vcc
    v_cndmask_b32_e64 v245, v241, v11, vcc
    v_cndmask_b32_e64 v246, v242, v11, vcc
    v_cndmask_b32_e64 v247, v243, v11, vcc
    v_mov_b64 v[200:201], 0
    v_mov_b64 v[202:203], 0
    v_mov_b64 v[204:205], 0
    v_mov_b64 v[206:207], 0
    v_mov_b64 v[208:209], 0
    v_mov_b64 v[210:211], 0
    v_mov_b64 v[212:213], 0
    v_mov_b64 v[214:215], 0
    v_mov_b64 v[216:217], 0
    v_mov_b64 v[218:219], 0
    v_mov_b64 v[220:221], 0
    v_mov_b64_e64 v[222:223], 0
    s_lshl1_add_u32 s69, s58, s70
    s_mul_i32 s69, s69, 7168
    s_mul_i32 s63, s59, 290816
    s_add_u32 s69, s69, s63
    s_lshl2_add_u32 s63, s70, s20
    v_mov_b32 v41, s63
    s_lshl_b32 s71, s70, 2
    v_and_b32 v120, 8, v0
    v_lshlrev_b32 v120, 6, v120
    v_lshlrev_b32_e64 v122, 5, v0
    v_bfi_b32 v122, v122, 0, v120
    s_bitcmp1_b32 s52, 0
    s_cselect_b32 s63, -1, 0
    v_and_b32 v121, s63, v120
    v_and_b32 v123, s63, v122
    v_sub_u32 v120, v251, v120
    v_sub_u32 v121, v251, v121
    v_sub_u32 v122, v252, v122
    v_sub_u32 v123, v252, v123
    v_mov_b32 v124, 159744
    v_mov_b32 v126, 1
    s_lshl_b32 s63, s70, 3
    s_lshl_b32 s63, 0x100, s63
    v_mov_b32_e64 v126, s63
    s_mov_b64 s[72:73], s[40:41]
    s_mov_b32 s63, 1
    s_mul_i32 s63, s63, 81920
    s_add_u32 s22, s63, s65
    s_mov_b32 s63, 2
    s_mul_i32 s63, s63, 81920
    s_add_u32 s23, s63, s65
    s_mov_b32 s63, 3
    s_mul_i32 s63, s63, 81920
    s_add_u32 s24, s63, s65
    s_mov_b32 s63, 4
    s_mul_i32 s63, s63, 81920
    s_add_u32 s25, s63, s65
    s_mul_i32 s84, s70, 35840
    s_add_u32 s84, s84, 38912
    s_and_b32 s63, s64, 1
    s_mul_i32 s82, s63, 1536
    s_lshl_b32 s83, s63, 9
    s_add_u32 s83, s83, 3584
    s_mov_b32 s62, 0x3ea52b5c
    s_mov_b32 s63, 0x3ea52b5c
    s_mov_b32 s61, 0
    s_cmp_eq_u32 s71, s56
    s_cbranch_scc1 L_sdone
    s_waitcnt vmcnt(0)
    buffer_load_dword v44, v41, s[40:43], 0 offen sc1
    s_sleep 2
L_spoll:
    buffer_load_dword v42, v41, s[40:43], 0 offen sc1
    s_add_u32 s61, s61, 1
    s_cmp_lt_u32 s61, 30000
    s_waitcnt vmcnt(1)
    v_cmp_eq_u32_e64 vcc, 0, v44
    s_cbranch_scc0 L_sok
    s_cbranch_vccz L_sok
    buffer_load_dword v44, v41, s[40:43], 0 offen sc1
    s_waitcnt vmcnt(1)
    v_cmp_eq_u32_e64 vcc, 0, v42
    s_cbranch_vccnz L_spoll
L_sok:
    s_add_u32 m0, s84, s82
    s_add_u32 s68, s69, s82
    buffer_load_dwordx4 v45, s[40:43], s68 offen offset:0 sc1 lds
    buffer_load_dwordx4 v45, s[40:43], s68 offen offset:1024 sc1 lds
    s_add_u32 m0, s84, s83
    s_add_u32 s68, s69, s83
    buffer_load_dwordx4 v45, s[40:43], s68 offen offset:0 sc1 lds
    buffer_load_dwordx4 v45, s[40:43], s68 offen offset:1024 sc1 lds
    buffer_load_dwordx4 v45, s[40:43], s68 offen offset:2048 sc1 lds
L_sdone:
L_cw_l:
    ds_read_b32 v47, v46
    s_waitcnt lgkmcnt(0)
    v_cmp_gt_u32_e64 vcc, 4, v47
    s_cbranch_vccnz L_cw_l
    s_setprio 1
    s_waitcnt vmcnt(0)
    s_branch L_units
L_cfin:
    s_mov_b64 exec, -1
    s_andn2_b32 s65, 0x7ff, s75
    s_lshr_b32 s63, s65, 1
    s_sub_u32 s79, s63, s79
    s_and_b32 s63, s65, 1
    s_cmp_eq_u32 s63, s55
    s_cselect_b32 s79, s79, 64
    v_lshlrev_b32 v88, 16, v224
    v_and_b32 v89, 0xffff0000, v224
    v_lshlrev_b32_e64 v90, 16, v225
    v_and_b32 v91, 0xffff0000, v225
    v_lshlrev_b32_e64 v92, 16, v226
    v_and_b32 v93, 0xffff0000, v226
    v_lshlrev_b32_e64 v94, 16, v227
    v_and_b32 v95, 0xffff0000, v227
    v_lshlrev_b32_e64 v96, 16, v228
    v_and_b32 v97, 0xffff0000, v228
    v_lshlrev_b32_e64 v98, 16, v229
    v_and_b32 v99, 0xffff0000, v229
    v_lshlrev_b32_e64 v100, 16, v230
    v_and_b32 v101, 0xffff0000, v230
    v_lshlrev_b32_e64 v102, 16, v231
    v_and_b32 v103, 0xffff0000, v231
    v_lshlrev_b32_e64 v104, 16, v232
    v_and_b32 v105, 0xffff0000, v232
    v_lshlrev_b32_e64 v106, 16, v233
    v_and_b32 v107, 0xffff0000, v233
    v_lshlrev_b32_e64 v108, 16, v234
    v_and_b32 v109, 0xffff0000, v234
    v_lshlrev_b32_e64 v110, 16, v235
    v_and_b32 v111, 0xffff0000, v235
    v_lshlrev_b32_e64 v112, 16, v236
    v_and_b32 v113, 0xffff0000, v236
    v_lshlrev_b32_e64 v114, 16, v237
    v_and_b32 v115, 0xffff0000, v237
    v_lshlrev_b32_e64 v116, 16, v238
    v_and_b32 v117, 0xffff0000, v238
    v_lshlrev_b32_e64 v118, 16, v239
    v_and_b32 v119, 0xffff0000, v239
    s_mov_b32 s61, 0
L_gchk:
    v_max_u32 v2, v86, v87
    v_cmp_eq_u32 vcc, -1, v2
    s_cbranch_vccnz L_gpoll
L_gok:
    s_mul_i32 s63, s52, 9216
    s_add_u32 s63, s63, 38912
    v_add_u32 v85, s63, v255
    v_sub_f32 v2, 1.0, v86
    v_sub_f32_e64 v3, 1.0, v87
    ds_write_b64 v85, v[86:87] offset:8192
    v_mul_f32 v88, v2, v88
    v_mul_f32 v89, v2, v89
    v_mul_f32 v90, v2, v90
    v_mul_f32 v91, v2, v91
    v_mul_f32 v92, v2, v92
    v_mul_f32 v93, v2, v93
    v_mul_f32 v94, v2, v94
    v_mul_f32 v95, v2, v95
    v_mul_f32 v96, v2, v96
    v_mul_f32 v97, v2, v97
    v_mul_f32 v98, v2, v98
    v_mul_f32 v99, v2, v99
    v_mul_f32 v100, v2, v100
    v_mul_f32 v101, v2, v101
    v_mul_f32 v102, v2, v102
    v_mul_f32 v103, v2, v103
    v_mul_f32 v104, v3, v104
    v_mul_f32 v105, v3, v105
    v_mul_f32 v106, v3, v106
    v_mul_f32 v107, v3, v107
    v_mul_f32 v108, v3, v108
    v_mul_f32 v109, v3, v109
    v_mul_f32 v110, v3, v110
    v_mul_f32 v111, v3, v111
    v_mul_f32 v112, v3, v112
    v_mul_f32 v113, v3, v113
    v_mul_f32 v114, v3, v114
    v_mul_f32 v115, v3, v115
    v_mul_f32 v116, v3, v116
    v_mul_f32 v117, v3, v117
    v_mul_f32 v118, v3, v118
    v_mul_f32 v119, v3, v119
    ds_write_b128 v85, v[88:91] offset:0
    ds_write_b128 v85, v[92:95] offset:1024
    ds_write_b128 v85, v[96:99] offset:2048
    ds_write_b128 v85, v[100:103] offset:3072
    ds_write_b128 v85, v[104:107] offset:4096
    ds_write_b128 v85, v[108:111] offset:5120
    ds_write_b128 v85, v[112:115] offset:6144
    ds_write_b128 v85, v[116:119] offset:7168
    s_lshr_b32 s63, s79, 4
    s_min_u32 s63, s63, 2
    s_add_u32 s63, s63, 1
    v_mov_b32 v1, s63
    ds_write_b32 v84, v1
    s_cmp_lt_u32 s79, 32
    s_cbranch_scc1 L_y
L_yret:
    s_waitcnt lgkmcnt(0)
    s_endpgm
L_gpoll:
    buffer_load_dword v86, v78, s[40:43], s67 offen offset:0 sc1
    buffer_load_dword v87, v79, s[40:43], s67 offen offset:64 sc1
    s_add_u32 s61, s61, 1
    s_cmp_lt_u32 s61, 30000
    s_waitcnt vmcnt(0)
    s_cbranch_scc1 L_gchk
    s_branch L_gok
L_y:
    s_and_b32 s63, s79, 15
    v_cmp_eq_u32 s[70:71], s63, v77
    s_cmp_lt_u32 s79, 16
    s_cselect_b64 s[68:69], -1, 0
    v_cndmask_b32_e64 v4, v3, v2, s[68:69]
    v_mov_b64 v[8:9], 0
    v_mov_b64 v[10:11], 0
    v_mov_b64 v[12:13], 0
    v_mov_b64 v[14:15], 0
    v_mov_b64 v[16:17], 0
    v_mov_b64 v[18:19], 0
    v_mov_b64 v[20:21], 0
    v_mov_b64_e64 v[22:23], 0
    v_add_u32 v7, 77824, v255
    s_mov_b64 exec, 0
    s_cmp_eq_u32 s52, 3
    s_cbranch_scc1 L_ydb
    s_branch L_yd
L_yhopret:
    s_mov_b64 exec, -1
    v_and_b32_e64 v1, 48, v0
    s_lshl_b32 s63, s58, 8
    s_add_u32 s63, s63, 5971968
    s_mov_b32 s61, 0
L_ypoll:
    buffer_load_dwordx4 v[136:139], v1, s[40:43], s63 offen offset:0 sc1
    buffer_load_dwordx4 v[140:143], v1, s[40:43], s63 offen offset:64 sc1
    buffer_load_dwordx4 v[144:147], v1, s[40:43], s63 offen offset:128 sc1
    buffer_load_dwordx4 v[148:151], v1, s[40:43], s63 offen offset:192 sc1
    s_add_u32 s61, s61, 1
    s_cmp_lt_u32 s61, 30000
    s_waitcnt vmcnt(0)
    s_nop 0
    v_max3_u32 v6, v136, v137, v138
    v_max3_u32 v6, v6, v139, v140
    v_max3_u32 v6, v6, v141, v142
    v_max3_u32 v6, v6, v143, v144
    v_max3_u32 v6, v6, v145, v146
    v_max3_u32 v6, v6, v147, v148
    v_max3_u32 v6, v6, v149, v150
    v_max_u32 v6, v6, v151
    v_cmp_eq_u32_e64 vcc, -1, v6
    s_cbranch_scc0 L_yok
    s_cbranch_vccz L_yok
    s_sleep 3
    s_branch L_ypoll
L_yok:
    s_mov_b64 exec, s[70:71]
    v_pk_mul_f32 v[8:9], v[136:137], v[4:5] op_sel_hi:[1,0]
    v_pk_mul_f32 v[10:11], v[138:139], v[4:5] op_sel_hi:[1,0]
    v_pk_mul_f32 v[12:13], v[140:141], v[4:5] op_sel_hi:[1,0]
    v_pk_mul_f32 v[14:15], v[142:143], v[4:5] op_sel_hi:[1,0]
    v_pk_mul_f32 v[16:17], v[144:145], v[4:5] op_sel_hi:[1,0]
    v_pk_mul_f32 v[18:19], v[146:147], v[4:5] op_sel_hi:[1,0]
    v_pk_mul_f32 v[20:21], v[148:149], v[4:5] op_sel_hi:[1,0]
    v_pk_mul_f32 v[22:23], v[150:151], v[4:5] op_sel_hi:[1,0]
    s_mov_b64 exec, -1
    ds_write_b128 v7, v[8:11] offset:0
    ds_write_b128 v7, v[12:15] offset:1024
    ds_write_b128 v7, v[16:19] offset:2048
    ds_write_b128 v7, v[20:23] offset:3072
    ds_write_b32 v84, v84 offset:16
    s_branch L_yret
L_ar_c:
    s_mov_b32 s21, 0
    v_mov_b32_e64 v1, s53
L_ar2_c:
    s_sleep 4
    buffer_load_dword v168, v1, s[40:43], 0 offen sc1
    buffer_load_dword v169, v1, s[40:43], 0 offen offset:128 sc1
    s_add_u32 s21, s21, 1
    s_waitcnt vmcnt(0)
    v_readfirstlane_b32 s0, v168
    v_readfirstlane_b32 s1, v169
    v_mov_b64_e64 v[168:169], 0
    s_cmp_lt_u32 s21, 30000
    s_cbranch_scc0 L_ao_c
    s_add_u32 s63, s0, s1
    s_lshr_b32 s61, s63, 4
    s_and_b32 s61, s61, 0x0f0f0f0f
    s_and_b32 s63, s63, 0x0f0f0f0f
    s_add_u32 s63, s63, s61
    s_mul_i32 s63, s63, 0x01010101
    s_lshr_b32 s63, s63, 24
    s_cmp_ge_u32 s63, 10
    s_cbranch_scc0 L_ar2_c
    s_branch L_ao_c
L_send1:
    v_lshlrev_b32 v1, 3, v0
    s_mov_b64 exec, s[64:65]
    buffer_store_dwordx2 v[32:33], v1, s[40:43], s61 offen offset:0 sc1
    buffer_store_dwordx2 v[4:5], v1, s[40:43], s80 offen offset:0 sc1
    buffer_store_dwordx2 v[36:37], v1, s[40:43], s61 offen offset:512 sc1
    buffer_store_dwordx2 v[8:9], v1, s[40:43], s80 offen offset:512 sc1
    buffer_store_dwordx2 v[40:41], v1, s[40:43], s61 offen offset:1024 sc1
    buffer_store_dwordx2 v[12:13], v1, s[40:43], s80 offen offset:1024 sc1
    buffer_store_dwordx2 v[44:45], v1, s[40:43], s61 offen offset:1536 sc1
    buffer_store_dwordx2 v[16:17], v1, s[40:43], s80 offen offset:1536 sc1
    buffer_store_dwordx2 v[48:49], v1, s[40:43], s61 offen offset:2048 sc1
    buffer_store_dwordx2 v[20:21], v1, s[40:43], s80 offen offset:2048 sc1
    buffer_store_dwordx2 v[52:53], v1, s[40:43], s61 offen offset:2560 sc1
    buffer_store_dwordx2 v[24:25], v1, s[40:43], s80 offen offset:2560 sc1
    buffer_store_dwordx2 v[56:57], v1, s[40:43], s61 offen offset:3072 sc1
    buffer_store_dwordx2 v[28:29], v1, s[40:43], s80 offen offset:3072 sc1
    s_mov_b64 exec, 1
    v_mov_b32_e64 v1, 0
    s_waitcnt vmcnt(0)
    buffer_store_dword v7, v1, s[40:43], s81 offen sc1
    s_mov_b64 exec, -1
    s_branch L_sent
L_xres_0:
    s_call_b64 s[26:27], L_xres
    s_branch L_xret_0
L_xres_1:
    s_call_b64 s[26:27], L_xres
    s_branch L_xret_1
L_xres_2:
    s_call_b64 s[26:27], L_xres
    s_branch L_xret_2
L_xres_3:
    s_call_b64 s[26:27], L_xres
    s_branch L_xret_3
L_xres_4:
    s_call_b64 s[26:27], L_xres
    s_branch L_xret_4
L_xres_5:
    s_call_b64 s[26:27], L_xres
    s_branch L_xret_5
L_xres_6:
    s_call_b64 s[26:27], L_xres
    s_branch L_xret_6
L_xres_7:
    s_call_b64 s[26:27], L_xres
    s_branch L_xret_7
L_xres_8:
    s_call_b64 s[26:27], L_xres
    s_branch L_xret_8
L_xres_9:
    s_call_b64 s[26:27], L_xres
    s_branch L_xret_9
L_xres:
    ds_read_b64 v[224:225], v3 offset:0
    ds_read_b64 v[232:233], v3 offset:2048
    v_xor_b32_e64 v3, 32, v3
    ds_read_b64 v[226:227], v3 offset:0
    ds_read_b64 v[234:235], v3 offset:2048
    v_xor_b32_e64 v3, 64, v3
    ds_read_b64 v[230:231], v3 offset:0
    ds_read_b64 v[238:239], v3 offset:2048
    v_xor_b32_e64 v3, 32, v3
    ds_read_b64 v[228:229], v3 offset:0
    ds_read_b64 v[236:237], v3 offset:2048
    s_setpc_b64 s[26:27]
L_keypoll:
    v_mov_b32_e64 v1, 0
    s_mov_b32 s61, 0
L_keypoll2:
    buffer_load_dword v2, v1, s[44:47], 0 offen sc1
    s_add_u32 s61, s61, 1
    s_waitcnt vmcnt(0)
    v_readfirstlane_b32 s75, v2
    s_cmp_lt_u32 s61, 30000
    s_cbranch_scc0 L_keyok
    s_cmp_eq_u32 s75, 0
    s_cbranch_scc0 L_keyok
    s_sleep 4
    s_branch L_keypoll2
L_mb0:
    s_waitcnt lgkmcnt(0)
    s_cmp_ge_u32 s21, 5
    s_cbranch_scc1 L_mb_ret
L_mb:
    s_load_dword s21, s[40:41], s20 glc
    s_add_u32 s61, s61, 1
    s_cmp_lt_u32 s61, 30000
    s_waitcnt lgkmcnt(0)
    s_cbranch_scc0 L_mb_ret
    s_cmp_ge_u32 s21, 5
    s_cbranch_scc0 L_mb
    s_branch L_mb_ret
    s_nop 0
L_gf:
    ds_read_b32 v2, v3
    s_waitcnt lgkmcnt(0)
    v_cmp_eq_u32 vcc, 0, v2
    s_cbranch_vccz L_gf_ret
    s_sleep 1
    s_branch L_gf
L_yd:
    s_cbranch_execz L_yd2
    v_add_u32 v1, 77824, v255
    ds_read_b32 v246, v3 offset:16
    ds_read_b128 v[188:191], v1 offset:0
    ds_read_b128 v[192:195], v1 offset:1024
    ds_read_b128 v[196:199], v1 offset:2048
    ds_read_b128 v[200:203], v1 offset:3072
    v_mfma_f32_16x16x32_bf16 v[4:7], v[140:143], v[76:79], v[4:7]
    v_mfma_f32_16x16x32_bf16 v[8:11], v[144:147], v[76:79], v[8:11]
    v_mfma_f32_16x16x32_bf16 v[12:15], v[148:151], v[76:79], v[12:15]
    v_mfma_f32_16x16x32_bf16 v[16:19], v[152:155], v[76:79], v[16:19]
    v_mfma_f32_16x16x32_bf16 v[20:23], v[140:143], v[80:83], v[20:23]
    v_mfma_f32_16x16x32_bf16 v[24:27], v[144:147], v[80:83], v[24:27]
    v_mfma_f32_16x16x32_bf16 v[28:31], v[148:151], v[80:83], v[28:31]
    v_mfma_f32_16x16x32_bf16 v[32:35], v[152:155], v[80:83], v[32:35]
L_yd1:
    s_waitcnt lgkmcnt(0)
    v_cmp_eq_u32 vcc, 0, v246
    s_cbranch_vccz L_yd2
    s_sleep 1
    ds_read_b32 v246, v3 offset:16
    ds_read_b128 v[188:191], v1 offset:0
    ds_read_b128 v[192:195], v1 offset:1024
    ds_read_b128 v[196:199], v1 offset:2048
    ds_read_b128 v[200:203], v1 offset:3072
    s_branch L_yd1
L_yd2:
    s_cbranch_execz L_yhopret
    v_cmp_eq_u32 vcc, 1, v2
    s_cbranch_vccz L_yd3
    v_pk_add_f32 v[156:157], v[156:157], v[188:189]
    v_pk_add_f32 v[158:159], v[158:159], v[190:191]
    v_pk_add_f32 v[160:161], v[160:161], v[192:193]
    v_pk_add_f32 v[162:163], v[162:163], v[194:195]
    v_pk_add_f32 v[164:165], v[164:165], v[196:197]
    v_pk_add_f32 v[166:167], v[166:167], v[198:199]
    v_pk_add_f32 v[168:169], v[168:169], v[200:201]
    v_pk_add_f32 v[170:171], v[170:171], v[202:203]
    s_branch L_ydret
    s_nop 0
L_yd3:
    v_pk_add_f32 v[172:173], v[172:173], v[188:189]
    v_pk_add_f32 v[174:175], v[174:175], v[190:191]
    v_pk_add_f32 v[176:177], v[176:177], v[192:193]
    v_pk_add_f32 v[178:179], v[178:179], v[194:195]
    v_pk_add_f32 v[180:181], v[180:181], v[196:197]
    v_pk_add_f32 v[182:183], v[182:183], v[198:199]
    v_pk_add_f32 v[184:185], v[184:185], v[200:201]
    v_pk_add_f32 v[186:187], v[186:187], v[202:203]
    s_branch L_ydret
L_mb0b:
    s_waitcnt lgkmcnt(0)
    s_cmp_ge_u32 s21, 5
    s_cbranch_scc1 L_mb_retb
L_mbb:
    s_load_dword s21, s[40:41], s20 glc
    s_add_u32 s61, s61, 1
    s_cmp_lt_u32 s61, 30000
    s_waitcnt lgkmcnt(0)
    s_cbranch_scc0 L_mb_retb
    s_cmp_ge_u32 s21, 5
    s_cbranch_scc0 L_mbb
    s_branch L_mb_retb
L_gfb:
    ds_read_b32 v2, v3
    s_waitcnt lgkmcnt(0)
    v_cmp_eq_u32 vcc, 0, v2
    s_cbranch_vccz L_gf_retb
    s_sleep 1
    s_branch L_gfb
L_ydb:
    s_cbranch_execz L_yd2b
    v_add_u32 v1, 77824, v255
    ds_read_b32 v246, v3 offset:16
    ds_read_b128 v[188:191], v1 offset:0
    ds_read_b128 v[192:195], v1 offset:1024
    ds_read_b128 v[196:199], v1 offset:2048
    ds_read_b128 v[200:203], v1 offset:3072
    v_mfma_f32_16x16x32_bf16 v[4:7], v[140:143], v[76:79], v[4:7]
    v_mfma_f32_16x16x32_bf16 v[8:11], v[144:147], v[76:79], v[8:11]
    v_mfma_f32_16x16x32_bf16 v[12:15], v[148:151], v[76:79], v[12:15]
    v_mfma_f32_16x16x32_bf16 v[16:19], v[152:155], v[76:79], v[16:19]
L_yd1b:
    s_waitcnt lgkmcnt(0)
    v_cmp_eq_u32 vcc, 0, v246
    s_cbranch_vccz L_yd2b
    s_sleep 1
    ds_read_b32 v246, v3 offset:16
    ds_read_b128 v[188:191], v1 offset:0
    ds_read_b128 v[192:195], v1 offset:1024
    ds_read_b128 v[196:199], v1 offset:2048
    ds_read_b128 v[200:203], v1 offset:3072
    s_branch L_yd1b
L_yd2b:
    s_cbranch_execz L_yhopret
    v_cmp_eq_u32 vcc, 1, v2
    s_cbranch_vccz L_yd3b
    v_pk_add_f32 v[156:157], v[156:157], v[188:189]
    v_pk_add_f32 v[158:159], v[158:159], v[190:191]
    v_pk_add_f32 v[160:161], v[160:161], v[192:193]
    v_pk_add_f32 v[162:163], v[162:163], v[194:195]
    v_pk_add_f32 v[164:165], v[164:165], v[196:197]
    v_pk_add_f32 v[166:167], v[166:167], v[198:199]
    v_pk_add_f32 v[168:169], v[168:169], v[200:201]
    v_pk_add_f32 v[170:171], v[170:171], v[202:203]
    s_branch L_ydretb
    s_nop 0
L_yd3b:
    v_pk_add_f32 v[172:173], v[172:173], v[188:189]
    v_pk_add_f32 v[174:175], v[174:175], v[190:191]
    v_pk_add_f32 v[176:177], v[176:177], v[192:193]
    v_pk_add_f32 v[178:179], v[178:179], v[194:195]
    v_pk_add_f32 v[180:181], v[180:181], v[196:197]
    v_pk_add_f32 v[182:183], v[182:183], v[198:199]
    v_pk_add_f32 v[184:185], v[184:185], v[200:201]
    v_pk_add_f32 v[186:187], v[186:187], v[202:203]
    s_branch L_ydretb
.p2align 12
L_aux:
    s_sub_u32 s56, s54, 25
    s_lshr_b32 s57, s56, 1
    s_lshl3_add_u32 s57, s57, s53
    s_and_b32 s63, s56, 1
    s_lshl1_add_u32 s57, s57, s63
    s_add_u32 s63, s53, 48
    s_cmp_eq_u32 s56, 6
    s_cselect_b32 s57, s63, s57
    v_lshrrev_b32 v1, 3, v0
    v_and_b32 v2, 7, v0
    s_cmp_ge_u32 s52, 5
    s_cbranch_scc1 L_aux_hi
    s_lshr_b32 s60, s53, 2
    s_and_b32 s63, s53, 1
    s_lshl1_add_u32 s60, s60, s63
    s_mul_i32 s59, s56, 5
    s_add_u32 s59, s59, s52
    s_lshl_b32 s60, s60, 8
    s_lshl3_add_u32 s60, s59, s60
    v_add_u32 v3, s60, v1
    v_lshl_add_u32 v4, v3, 1, s55
    v_mul_u32_u24 v5, 1280, v4
    v_lshl_add_u32 v5, v2, 4, v5
    s_cmp_lt_u32 s59, 32
    s_cselect_b32 s63, 0, 0x80000000
    v_or_b32_e64 v5, s63, v5
    s_waitcnt lgkmcnt(0)
    s_mov_b64 s[28:29], s[4:5]
    s_mov_b64 s[32:33], s[6:7]
    buffer_load_dwordx4 v[8:11], v5, s[28:31], 0 offen offset:0
    buffer_load_dwordx4 v[12:15], v5, s[28:31], 0 offen offset:128
    s_barrier
    buffer_load_dwordx4 v[16:19], v5, s[28:31], 0 offen offset:256
    buffer_load_dwordx4 v[20:23], v5, s[28:31], 0 offen offset:384
    s_barrier
    buffer_load_dwordx4 v[24:27], v5, s[28:31], 0 offen offset:512
    buffer_load_dwordx4 v[28:31], v5, s[28:31], 0 offen offset:640
    s_barrier
    buffer_load_dwordx4 v[32:35], v5, s[28:31], 0 offen offset:768
    buffer_load_dwordx4 v[36:39], v5, s[28:31], 0 offen offset:896
    s_barrier
    buffer_load_dwordx4 v[40:43], v5, s[28:31], 0 offen offset:1024
    buffer_load_dwordx4 v[44:47], v5, s[28:31], 0 offen offset:1152
    s_mov_b64 s[36:37], s[8:9]
    s_mov_b64 s[40:41], s[26:27]
    s_mov_b64 s[44:45], s[24:25]
    s_mov_b64 s[48:49], s[22:23]
    s_mov_b32 s38, 819200
    s_mov_b32 s39, 0x20000
    s_mov_b32 s42, 20971520
    s_mov_b32 s43, 0x20000
    s_mov_b32 s46, 256
    s_mov_b32 s47, 0x20000
    s_mov_b32 s50, 2621440
    s_mov_b32 s51, 0x20000
    v_mov_b32 v136, 252
    v_lshlrev_b32_e64 v6, 4, v2
    v_add_u32 v6, 122880, v6
    s_barrier
    v_mov_b32 v7, 129536
    s_cmp_lt_u32 s59, 32
    s_cbranch_scc1 L_aux_rg
    s_mov_b64 s[64:65], s[40:41]
    s_mov_b32 s66, 5961472
    s_mov_b32 s67, 0x20000
    v_mov_b32 v132, -1
    v_mov_b32 v133, -1
    v_mov_b32 v134, -1
    v_mov_b32 v135, -1
    s_mul_i32 s63, s53, 3
    s_add_u32 s63, s63, s52
    s_mul_i32 s63, s63, 6144
    s_add_u32 s63, s63, 5804032
    v_lshl_add_u32 v5, v0, 4, s63
    v_add_u32 v6, 3072, v5
    buffer_store_dwordx4 v[132:135], v5, s[64:67], 0 offen offset:0 sc1
    buffer_store_dwordx4 v[132:135], v5, s[64:67], 0 offen offset:1024 sc1
    buffer_store_dwordx4 v[132:135], v5, s[64:67], 0 offen offset:2048 sc1
    buffer_store_dwordx4 v[132:135], v6, s[64:67], 0 offen offset:0 sc1
    buffer_store_dwordx4 v[132:135], v6, s[64:67], 0 offen offset:1024 sc1
    buffer_store_dwordx4 v[132:135], v6, s[64:67], 0 offen offset:2048 sc1
    s_waitcnt vmcnt(0)
    s_load_dword s85, s[44:45], 252
    s_branch L_aux_rgdone
L_aux_rg:
    ds_read_b128 v[48:51], v6 offset:0
    ds_read_b128 v[52:55], v6 offset:2048
    ds_read_b128 v[56:59], v6 offset:128
    ds_read_b128 v[60:63], v6 offset:2176
    ds_read_b128 v[64:67], v6 offset:256
    ds_read_b128 v[68:71], v6 offset:2304
    ds_read_b128 v[72:75], v6 offset:384
    ds_read_b128 v[76:79], v6 offset:2432
    ds_read_b128 v[80:83], v6 offset:512
    ds_read_b128 v[84:87], v6 offset:2560
    ds_read_b128 v[88:91], v6 offset:640
    ds_read_b128 v[92:95], v6 offset:2688
    ds_read_b128 v[96:99], v6 offset:768
    ds_read_b128 v[100:103], v6 offset:2816
    ds_read_b128 v[104:107], v6 offset:896
    ds_read_b128 v[108:111], v6 offset:2944
    ds_read_b128 v[112:115], v6 offset:1024
    ds_read_b128 v[116:119], v6 offset:3072
    ds_read_b128 v[120:123], v6 offset:1152
    ds_read_b128 v[124:127], v6 offset:3200
    v_mov_b32 v128, 0
    v_mov_b32 v129, 0
    v_mov_b32 v130, 0
    v_mov_b32_e64 v131, 0
    s_waitcnt vmcnt(0) lgkmcnt(0)
    s_load_dword s85, s[44:45], 252
    v_dot2c_f32_bf16 v128, v8, v48
    v_dot2c_f32_bf16 v130, v8, v52
    v_dot2c_f32_bf16 v129, v9, v49
    v_dot2c_f32_bf16 v131, v9, v53
    v_dot2c_f32_bf16 v128, v10, v50
    v_dot2c_f32_bf16 v130, v10, v54
    v_dot2c_f32_bf16 v129, v11, v51
    v_dot2c_f32_bf16 v131, v11, v55
    v_dot2c_f32_bf16 v128, v12, v56
    v_dot2c_f32_bf16 v130, v12, v60
    v_dot2c_f32_bf16 v129, v13, v57
    v_dot2c_f32_bf16 v131, v13, v61
    v_dot2c_f32_bf16 v128, v14, v58
    v_dot2c_f32_bf16 v130, v14, v62
    v_dot2c_f32_bf16 v129, v15, v59
    v_dot2c_f32_bf16 v131, v15, v63
    v_dot2c_f32_bf16 v128, v16, v64
    v_dot2c_f32_bf16 v130, v16, v68
    v_dot2c_f32_bf16 v129, v17, v65
    v_dot2c_f32_bf16 v131, v17, v69
    v_dot2c_f32_bf16 v128, v18, v66
    v_dot2c_f32_bf16 v130, v18, v70
    v_dot2c_f32_bf16 v129, v19, v67
    v_dot2c_f32_bf16 v131, v19, v71
    v_dot2c_f32_bf16 v128, v20, v72
    v_dot2c_f32_bf16 v130, v20, v76
    v_dot2c_f32_bf16 v129, v21, v73
    v_dot2c_f32_bf16 v131, v21, v77
    v_dot2c_f32_bf16 v128, v22, v74
    v_dot2c_f32_bf16 v130, v22, v78
    v_dot2c_f32_bf16 v129, v23, v75
    v_dot2c_f32_bf16 v131, v23, v79
    v_dot2c_f32_bf16 v128, v24, v80
    v_dot2c_f32_bf16 v130, v24, v84
    v_dot2c_f32_bf16 v129, v25, v81
    v_dot2c_f32_bf16 v131, v25, v85
    v_dot2c_f32_bf16 v128, v26, v82
    v_dot2c_f32_bf16 v130, v26, v86
    v_dot2c_f32_bf16 v129, v27, v83
    v_dot2c_f32_bf16 v131, v27, v87
    v_dot2c_f32_bf16 v128, v28, v88
    v_dot2c_f32_bf16 v130, v28, v92
    v_dot2c_f32_bf16 v129, v29, v89
    v_dot2c_f32_bf16 v131, v29, v93
    v_dot2c_f32_bf16 v128, v30, v90
    v_dot2c_f32_bf16 v130, v30, v94
    v_dot2c_f32_bf16 v129, v31, v91
    v_dot2c_f32_bf16 v131, v31, v95
    v_dot2c_f32_bf16 v128, v32, v96
    v_dot2c_f32_bf16 v130, v32, v100
    v_dot2c_f32_bf16 v129, v33, v97
    v_dot2c_f32_bf16 v131, v33, v101
    v_dot2c_f32_bf16 v128, v34, v98
    v_dot2c_f32_bf16 v130, v34, v102
    v_dot2c_f32_bf16 v129, v35, v99
    v_dot2c_f32_bf16 v131, v35, v103
    v_dot2c_f32_bf16 v128, v36, v104
    v_dot2c_f32_bf16 v130, v36, v108
    v_dot2c_f32_bf16 v129, v37, v105
    v_dot2c_f32_bf16 v131, v37, v109
    v_dot2c_f32_bf16 v128, v38, v106
    v_dot2c_f32_bf16 v130, v38, v110
    v_dot2c_f32_bf16 v129, v39, v107
    v_dot2c_f32_bf16 v131, v39, v111
    v_dot2c_f32_bf16 v128, v40, v112
    v_dot2c_f32_bf16 v130, v40, v116
    v_dot2c_f32_bf16 v129, v41, v113
    v_dot2c_f32_bf16 v131, v41, v117
    v_dot2c_f32_bf16 v128, v42, v114
    v_dot2c_f32_bf16 v130, v42, v118
    v_dot2c_f32_bf16 v129, v43, v115
    v_dot2c_f32_bf16 v131, v43, v119
    v_dot2c_f32_bf16 v128, v44, v120
    v_dot2c_f32_bf16 v130, v44, v124
    v_dot2c_f32_bf16 v129, v45, v121
    v_dot2c_f32_bf16 v131, v45, v125
    v_dot2c_f32_bf16 v128, v46, v122
    v_dot2c_f32_bf16 v130, v46, v126
    v_dot2c_f32_bf16 v129, v47, v123
    v_dot2c_f32_bf16 v131, v47, v127
    s_nop 1
    v_add_f32 v128, v128, v129
    v_add_f32 v130, v130, v131
    s_nop 0
    v_add_f32_dpp v128, v128, v128 quad_perm:[1,0,3,2] row_mask:0xf bank_mask:0xf
    v_add_f32_dpp v130, v130, v130 quad_perm:[1,0,3,2] row_mask:0xf bank_mask:0xf
    s_nop 0
    v_add_f32_dpp v128, v128, v128 quad_perm:[2,3,0,1] row_mask:0xf bank_mask:0xf
    v_add_f32_dpp v130, v130, v130 quad_perm:[2,3,0,1] row_mask:0xf bank_mask:0xf
    s_nop 0
    v_add_f32_dpp v128, v128, v128 row_half_mirror row_mask:0xf bank_mask:0xf
    v_add_f32_dpp v130, v130, v130 row_half_mirror row_mask:0xf bank_mask:0xf
    v_cvt_pk_bf16_f32 v130, v130, v130
    v_and_b32 v130, 0xffff0000, v130
    v_mul_f32 v130, 0xbfb8aa3b, v130
    v_exp_f32 v130, v130
    s_nop 0
    v_add_f32 v130, 1.0, v130
    v_rcp_f32_e64 v130, v130
    s_nop 0
    v_cvt_pk_bf16_f32 v130, v130, v130
    v_and_b32 v130, 0xffff0000, v130
    v_cvt_pk_bf16_f32 v128, v128, v128
    v_and_b32 v128, 0xffff0000, v128
    v_ashrrev_i32_e64 v129, 31, v128
    v_or_b32 v129, 0x80000000, v129
    v_xor_b32_e64 v128, v128, v129
    v_and_b32 v128, 0xffff0000, v128
    v_sub_u32 v129, 0xffff, v4
    v_or_b32 v128, v128, v129
L_aux_rgdone:
    s_lshl_b32 s63, s55, 12
    s_add_u32 s63, s63, 5963776
    v_lshlrev_b32 v3, 2, v3
    s_mov_b32 s61, 0
    s_waitcnt lgkmcnt(0)
    v_mov_b32 v137, s85
L_aux_init:
    v_cmp_eq_u32 vcc, 0, v137
    s_cbranch_vccz L_aux_initok
    buffer_load_dword v137, v136, s[44:47], 0 offen sc1
    s_add_u32 s61, s61, 1
    s_cmp_lt_u32 s61, 30000
    s_waitcnt vmcnt(0)
    s_cbranch_scc1 L_aux_init
L_aux_initok:
    s_cmp_lt_u32 s59, 32
    s_cbranch_scc0 L_aux_norg
    s_mov_b32 exec_lo, 0x01010101
    s_mov_b32 exec_hi, 0x01010101
    ds_max_u32 v7, v128
    buffer_store_dword v130, v3, s[40:43], s63 offen sc1
L_aux_norg:
L_aux_arr:
    s_mov_b64 exec, 1
    v_mov_b32 v129, 1
    s_waitcnt lgkmcnt(0)
    ds_add_rtn_u32 v131, v7, v129 offset:4
    ds_read_b32 v128, v7
    s_lshl4_add_u32 s63, s56, s53
    s_lshl_b32 s63, s63, 2
    s_add_u32 s63, s63, 5980160
    s_waitcnt lgkmcnt(0)
    v_cmp_eq_u32 vcc, 4, v131
    v_readfirstlane_b32 s61, v128
    s_cbranch_vccz L_aux_nopub
    s_atomic_add s61, s[40:41], s63
    s_waitcnt lgkmcnt(0)
L_aux_nopub:
    s_mov_b64 exec, -1
    s_cmp_ge_u32 s57, 54
    s_cbranch_scc0 L_aux_ffn
    s_lshl3_add_u32 s63, s2, s52
    s_cmp_eq_u32 s63, 2044
    s_cbranch_scc0 L_aux_end
    s_add_u32 s54, s40, 5980160
    s_addc_u32 s55, s41, 0
    s_mov_b32 s63, 0
L_aux_col:
    s_load_dwordx8 s[4:11], s[54:55], 0 glc
    s_load_dwordx8 s[12:19], s[54:55], 64 glc
    s_load_dwordx8 s[20:27], s[54:55], 128 glc
    s_load_dwordx8 s[28:35], s[54:55], 192 glc
    s_load_dwordx8 s[64:71], s[54:55], 256 glc
    s_load_dwordx8 s[72:79], s[54:55], 320 glc
    s_load_dwordx8 s[80:87], s[54:55], 384 glc
    s_add_u32 s63, s63, 1
    s_waitcnt lgkmcnt(0)
    s_and_b64 s[36:37], s[4:5], s[6:7]
    s_and_b64 s[36:37], s[36:37], s[8:9]
    s_and_b64 s[36:37], s[36:37], s[10:11]
    s_and_b64 s[36:37], s[36:37], s[12:13]
    s_and_b64 s[36:37], s[36:37], s[14:15]
    s_and_b64 s[36:37], s[36:37], s[16:17]
    s_and_b64 s[36:37], s[36:37], s[18:19]
    s_and_b64 s[36:37], s[36:37], s[20:21]
    s_and_b64 s[36:37], s[36:37], s[22:23]
    s_and_b64 s[36:37], s[36:37], s[24:25]
    s_and_b64 s[36:37], s[36:37], s[26:27]
    s_and_b64 s[36:37], s[36:37], s[28:29]
    s_and_b64 s[36:37], s[36:37], s[30:31]
    s_and_b64 s[36:37], s[36:37], s[32:33]
    s_and_b64 s[36:37], s[36:37], s[34:35]
    s_and_b64 s[36:37], s[36:37], s[64:65]
    s_and_b64 s[36:37], s[36:37], s[66:67]
    s_and_b64 s[36:37], s[36:37], s[68:69]
    s_and_b64 s[36:37], s[36:37], s[70:71]
    s_and_b64 s[36:37], s[36:37], s[72:73]
    s_and_b64 s[36:37], s[36:37], s[74:75]
    s_and_b64 s[36:37], s[36:37], s[76:77]
    s_and_b64 s[36:37], s[36:37], s[78:79]
    s_and_b64 s[36:37], s[36:37], s[80:81]
    s_and_b64 s[36:37], s[36:37], s[82:83]
    s_and_b64 s[36:37], s[36:37], s[84:85]
    s_and_b64 s[36:37], s[36:37], s[86:87]
    s_cmp_lt_u32 s63, 30000
    s_cbranch_scc0 L_aux_colok
    s_and_b32 s36, s36, s37
    s_cbranch_scc0 L_aux_col
L_aux_colok:
    s_max_u32 s36, s4, s5
    s_max_u32 s36, s36, s6
    s_max_u32 s36, s36, s7
    s_max_u32 s36, s36, s8
    s_max_u32 s36, s36, s9
    s_max_u32 s36, s36, s10
    s_max_u32 s36, s36, s11
    s_max_u32 s36, s36, s12
    s_max_u32 s36, s36, s13
    s_max_u32 s36, s36, s14
    s_max_u32 s36, s36, s15
    s_max_u32 s36, s36, s16
    s_max_u32 s36, s36, s17
    s_max_u32 s36, s36, s18
    s_max_u32 s36, s36, s19
    s_max_u32 s36, s36, s20
    s_max_u32 s36, s36, s21
    s_max_u32 s36, s36, s22
    s_max_u32 s36, s36, s23
    s_max_u32 s36, s36, s24
    s_max_u32 s36, s36, s25
    s_max_u32 s36, s36, s26
    s_max_u32 s36, s36, s27
    s_max_u32 s36, s36, s28
    s_max_u32 s36, s36, s29
    s_max_u32 s36, s36, s30
    s_max_u32 s36, s36, s31
    s_max_u32 s36, s36, s32
    s_max_u32 s36, s36, s33
    s_max_u32 s36, s36, s34
    s_max_u32 s36, s36, s35
    s_max_u32 s36, s36, s64
    s_max_u32 s36, s36, s65
    s_max_u32 s36, s36, s66
    s_max_u32 s36, s36, s67
    s_max_u32 s36, s36, s68
    s_max_u32 s36, s36, s69
    s_max_u32 s36, s36, s70
    s_max_u32 s36, s36, s71
    s_max_u32 s36, s36, s72
    s_max_u32 s36, s36, s73
    s_max_u32 s36, s36, s74
    s_max_u32 s36, s36, s75
    s_max_u32 s36, s36, s76
    s_max_u32 s36, s36, s77
    s_max_u32 s36, s36, s78
    s_max_u32 s36, s36, s79
    s_max_u32 s36, s36, s80
    s_max_u32 s36, s36, s81
    s_max_u32 s36, s36, s82
    s_max_u32 s36, s36, s83
    s_max_u32 s36, s36, s84
    s_max_u32 s36, s36, s85
    s_max_u32 s36, s36, s86
    s_max_u32 s36, s36, s87
    s_mov_b32 s61, s36
    s_atomic_add s61, s[54:55], 8192
    s_atomic_add s61, s[54:55], 8320
    s_atomic_add s61, s[54:55], 8448
    s_atomic_add s61, s[54:55], 8576
    s_atomic_add s61, s[54:55], 8704
    s_atomic_add s61, s[54:55], 8832
    s_atomic_add s61, s[54:55], 8960
    s_atomic_add s61, s[54:55], 9088
    s_atomic_add s61, s[54:55], 9216
    s_atomic_add s61, s[54:55], 9344
    s_atomic_add s61, s[54:55], 9472
    s_atomic_add s61, s[54:55], 9600
    s_atomic_add s61, s[54:55], 9728
    s_atomic_add s61, s[54:55], 9856
    s_atomic_add s61, s[44:45], 0
    s_waitcnt lgkmcnt(0)
    s_branch L_aux_end
L_aux_ffn:
    s_cmp_eq_u32 s52, 4
    s_cbranch_scc0 L_aux_f1
    s_lshr_b32 s63, s57, 2
    s_lshl_b32 s63, s63, 7
    s_add_u32 s63, s63, 5988352
    s_mov_b32 s61, 0
L_aux_key:
    s_load_dword s84, s[40:41], s63 glc
    s_add_u32 s61, s61, 1
    s_waitcnt lgkmcnt(0)
    s_cmp_lt_u32 s61, 30000
    s_cselect_b32 s84, s84, 1
    s_cmp_eq_u32 s84, 0
    s_cbranch_scc1 L_aux_key
    s_andn2_b32 s85, 0x7ff, s84
    s_mul_i32 s85, s85, 1280
    v_lshl_add_u32 v1, v0, 4, s85
    s_mov_b32 m0, 126976
    s_nop 0
    buffer_load_dwordx4 v1, s[28:31], 0 offen lds
    buffer_load_dwordx4 v1, s[28:31], 0 offen offset:1024 lds
    v_mov_b32_e64 v2, s84
    s_waitcnt vmcnt(0)
    ds_write_b32 v7, v2 offset:8
    s_waitcnt lgkmcnt(0)
    v_and_b32 v1, 31, v0
    v_lshlrev_b32_e64 v1, 2, v1
    s_and_b32 s63, s57, 1
    s_lshl_b32 s63, s63, 7
    s_sub_u32 s63, 129152, s63
    v_add_u32 v3, s63, v1
    s_lshl_b32 s63, s57, 7
    s_add_u32 s63, s63, 5954560
    s_mov_b32 s61, 0
    s_barrier
    s_barrier
    s_add_u32 s85, s63, 64
    v_mov_b32_e64 v2, 0
L_aux_x:
    s_load_dwordx16 s[4:19], s[40:41], s63 glc
    s_load_dwordx16 s[64:79], s[40:41], s85 glc
    s_add_u32 s61, s61, 1
    s_waitcnt lgkmcnt(0)
    s_max_u32 s20, s4, s64
    s_cmp_lt_u32 s61, 30000
    s_cselect_b32 s20, s20, 0
    s_cmp_eq_u32 s20, -1
    s_cbranch_scc1 L_aux_x
    v_writelane_b32 v2, s4, 0
    v_writelane_b32 v2, s5, 1
    v_writelane_b32 v2, s6, 2
    v_writelane_b32 v2, s7, 3
    v_writelane_b32 v2, s8, 4
    v_writelane_b32 v2, s9, 5
    v_writelane_b32 v2, s10, 6
    v_writelane_b32 v2, s11, 7
    v_writelane_b32 v2, s12, 8
    v_writelane_b32 v2, s13, 9
    v_writelane_b32 v2, s14, 10
    v_writelane_b32 v2, s15, 11
    v_writelane_b32 v2, s16, 12
    v_writelane_b32 v2, s17, 13
    v_writelane_b32 v2, s18, 14
    v_writelane_b32 v2, s19, 15
    v_writelane_b32 v2, s64, 16
    v_writelane_b32 v2, s65, 17
    v_writelane_b32 v2, s66, 18
    v_writelane_b32 v2, s67, 19
    v_writelane_b32 v2, s68, 20
    v_writelane_b32 v2, s69, 21
    v_writelane_b32 v2, s70, 22
    v_writelane_b32 v2, s71, 23
    v_writelane_b32 v2, s72, 24
    v_writelane_b32 v2, s73, 25
    v_writelane_b32 v2, s74, 26
    v_writelane_b32 v2, s75, 27
    v_writelane_b32 v2, s76, 28
    v_writelane_b32 v2, s77, 29
    v_writelane_b32 v2, s78, 30
    v_writelane_b32 v2, s79, 31
    s_cmp_lt_u32 s61, 30000
    v_cmp_eq_u32 vcc, -1, v2
    s_cbranch_scc0 L_aux_xok
    s_cbranch_vccnz L_aux_x
L_aux_xok:
    s_mov_b32 exec_hi, 0
    ds_write_b32 v3, v2
    s_mov_b32 exec_hi, -1
    s_waitcnt lgkmcnt(0)
    s_barrier
    s_barrier
    s_branch L_aux_d2
L_aux_hi:
    s_sub_u32 s84, s52, 5
    s_cmp_eq_u32 s84, 0
    s_cbranch_scc0 L_aux_w67
    v_mul_u32_u24 v3, 4370, v0
    v_lshrrev_b32 v3, 16, v3
    v_mul_u32_u24 v4, 15, v3
    v_sub_u32 v4, v0, v4
    v_mul_u32_u24 v5, 52, v4
    v_lshrrev_b32_e64 v5, 8, v5
    v_mul_u32_u24 v5, 640, v5
    v_lshl_add_u32 v5, v4, 7, v5
    v_mul_u32_u24 v3, 15360, v3
    s_lshr_b32 s63, s53, 1
    s_lshl4_add_u32 s63, s56, s63
    s_mul_i32 s63, s63, 6
    s_and_b32 s59, s53, 1
    s_add_u32 s63, s63, s59
    s_mul_i32 s63, s63, 640
    v_add3_u32 v5, s63, v5, v3
    v_cmp_gt_u32 vcc, 60, v0
    v_bfrev_b32 v6, 1
    s_nop 0
    v_cndmask_b32_e64 v5, v6, v5, vcc
    s_waitcnt lgkmcnt(0)
    s_mov_b64 s[28:29], s[4:5]
    s_mov_b64 s[32:33], s[6:7]
    s_mov_b32 s63, 0
    buffer_load_dword v10, v5, s[32:35], s63 offen
    s_mov_b32 s63, 430080
    buffer_load_dword v11, v5, s[32:35], s63 offen
    s_barrier
    s_mov_b32 s63, 860160
    buffer_load_dword v12, v5, s[32:35], s63 offen
    s_barrier
    s_mov_b32 s63, 1290240
    buffer_load_dword v13, v5, s[32:35], s63 offen
    s_barrier
    s_mov_b32 s63, 1720320
    buffer_load_dword v14, v5, s[32:35], s63 offen
    s_barrier
    s_mov_b32 s63, 2150400
    buffer_load_dword v15, v5, s[32:35], s63 offen
    s_barrier
    s_mov_b64 s[36:37], s[8:9]
    s_mov_b64 s[40:41], s[26:27]
    s_mov_b64 s[44:45], s[24:25]
    s_mov_b64 s[48:49], s[22:23]
    s_nop 0
    s_mov_b32 s38, 819200
    s_mov_b32 s39, 0x20000
    s_mov_b32 s42, 20971520
    s_mov_b32 s43, 0x20000
    s_mov_b32 s46, 256
    s_mov_b32 s47, 0x20000
    s_mov_b32 s50, 2621440
    s_mov_b32 s51, 0x20000
    s_branch L_aux_hi2
L_aux_w67:
    v_lshlrev_b32 v6, 4, v0
    v_mov_b32 v7, 129536
    v_mov_b32 v8, 0
    v_mov_b32 v9, 0
    ds_write_b64 v7, v[8:9]
    ds_write_b64 v7, v[8:9] offset:8
    s_mov_b32 s78, 1280
    s_mov_b32 s79, 0x20000
    s_mov_b32 s82, 1280
    s_mov_b32 s83, 0x20000
    s_waitcnt lgkmcnt(0)
    s_mov_b64 s[28:29], s[4:5]
    s_mov_b64 s[32:33], s[6:7]
    s_mov_b64 s[36:37], s[8:9]
    s_mov_b64 s[40:41], s[26:27]
    s_mov_b64 s[44:45], s[24:25]
    s_mov_b64 s[48:49], s[22:23]
    s_nop 0
    s_mov_b32 s38, 819200
    s_mov_b32 s39, 0x20000
    s_mov_b32 s42, 20971520
    s_mov_b32 s43, 0x20000
    s_mov_b32 s46, 256
    s_mov_b32 s47, 0x20000
    s_mov_b32 s50, 2621440
    s_mov_b32 s51, 0x20000
    s_mov_b64 s[76:77], s[12:13]
    s_mov_b64 s[80:81], s[20:21]
    s_cmp_eq_u32 s84, 1
    s_cbranch_scc0 L_aux_w7
    s_mov_b32 m0, 122880
    s_nop 0
    buffer_load_dwordx4 v6, s[76:79], 0 offen lds
    buffer_load_dwordx4 v6, s[76:79], 0 offen offset:1024 lds
    s_mov_b32 m0, 124928
    s_nop 0
    buffer_load_dwordx4 v6, s[80:83], 0 offen lds
    buffer_load_dwordx4 v6, s[80:83], 0 offen offset:1024 lds
L_aux_w7:
    v_lshlrev_b32 v3, 7, v0
    s_lshl3_add_u32 s59, s2, s52
    s_cmp_eq_u32 s59, 2047
    s_cbranch_scc0 L_aux_nn0
    v_mov_b32 v12, -1
    v_mov_b32 v13, -1
    v_mov_b32 v14, -1
    v_mov_b32 v15, -1
    v_lshlrev_b32 v10, 3, v0
    s_mov_b32 s63, 5980160
    buffer_store_dwordx2 v[8:9], v10, s[40:43], s63 offen sc1
    s_mov_b32 s63, 5988352
    s_mov_b32 exec_hi, 0x3fffff
    buffer_store_dword v8, v3, s[40:43], s63 offen sc1
    s_mov_b32 exec_hi, -1
    s_nop 0
    s_mov_b32 s63, 5963776
    buffer_store_dwordx4 v[12:15], v6, s[40:43], s63 offen offset:0 sc1
    buffer_store_dwordx4 v[12:15], v6, s[40:43], s63 offen offset:1024 sc1
    buffer_store_dwordx4 v[12:15], v6, s[40:43], s63 offen offset:2048 sc1
    buffer_store_dwordx4 v[12:15], v6, s[40:43], s63 offen offset:3072 sc1
    s_mov_b32 s63, 5967872
    buffer_store_dwordx4 v[12:15], v6, s[40:43], s63 offen offset:0 sc1
    buffer_store_dwordx4 v[12:15], v6, s[40:43], s63 offen offset:1024 sc1
    buffer_store_dwordx4 v[12:15], v6, s[40:43], s63 offen offset:2048 sc1
    buffer_store_dwordx4 v[12:15], v6, s[40:43], s63 offen offset:3072 sc1
    s_mov_b32 s63, 5971968
    buffer_store_dwordx4 v[12:15], v6, s[40:43], s63 offen offset:0 sc1
    buffer_store_dwordx4 v[12:15], v6, s[40:43], s63 offen offset:1024 sc1
    buffer_store_dwordx4 v[12:15], v6, s[40:43], s63 offen offset:2048 sc1
L_aux_nn0:
    s_barrier
    s_cmp_eq_u32 s59, 2047
    s_cbranch_scc0 L_aux_nn1
    s_waitcnt vmcnt(0)
    s_mov_b32 s85, 1
    s_atomic_add s85, s[44:45], 252
L_aux_nn1:
    s_barrier
    s_barrier
    s_barrier
    s_waitcnt vmcnt(0)
    s_barrier
L_aux_hi2:
    v_mul_u32_u24 v12, 4370, v0
    v_lshrrev_b32 v12, 16, v12
    v_mul_u32_u24 v13, 15, v12
    v_sub_u32 v13, v0, v13
    v_mul_u32_u24 v14, 52, v13
    v_lshrrev_b32 v14, 8, v14
    v_mul_u32_u24 v14, 640, v14
    v_lshl_add_u32 v14, v13, 7, v14
    v_mul_u32_u24 v12, 15360, v12
    s_bfe_u32 s63, s2, 0x20001
    s_mul_i32 s63, s63, 6
    s_and_b32 s61, s2, 1
    s_add_u32 s63, s63, s61
    s_mul_i32 s63, s63, 640
    v_add3_u32 v14, s63, v14, v12
    s_bfe_u32 s82, s2, 0x20001
    s_mul_i32 s63, s82, 3840
    v_subrev_u32 v14, s63, v14
    v_cmp_gt_u32 vcc, 60, v0
    v_bfrev_b32_e64 v12, 1
    s_nop 0
    v_cndmask_b32_e64 v14, v12, v14, vcc
    s_and_b32 s63, s53, 5
    s_xor_b32 s63, s63, 1
    s_lshr_b32 s61, s63, 2
    s_and_b32 s63, s63, 1
    s_lshl1_add_u32 s63, s61, s63
    s_lshl_b32 s63, s63, 9
    s_add_u32 s63, s63, s55
    s_mul_i32 s63, s63, 1280
    v_mul_u32_u24 v15, 2560, v0
    v_add_u32 v15, s63, v15
    s_mul_i32 s61, s84, 7
    s_add_u32 s61, s61, s56
    s_add_u32 s61, s61, 80
L_l2:
    s_waitcnt vmcnt(1)
    s_and_b32 s63, s61, 15
    s_lshr_b32 s59, s61, 4
    s_cmp_lt_u32 s63, 12
    s_cbranch_scc1 L_l2w
    s_sub_u32 s63, s63, 12
    s_mul_i32 s63, s63, 163840
    s_lshl_b32 s59, s59, 7
    s_add_u32 s63, s63, s59
    buffer_load_dword v10, v15, s[28:31], s63 offen
    s_branch L_l2n
L_l2w:
    s_lshr_b32 s83, s63, 2
    s_add_u32 s83, s83, s82
    s_add_u32 s83, s83, 1
    s_and_b32 s83, s83, 3
    s_and_b32 s63, s63, 3
    s_lshl2_add_u32 s63, s59, s63
    s_lshl4_add_u32 s63, s63, s83
    s_mul_i32 s63, s63, 3840
    buffer_load_dword v10, v14, s[32:35], s63 offen
L_l2n:
    s_add_u32 s61, s61, 21
    s_cmp_lt_u32 s61, 160
    s_cbranch_scc1 L_l2
    s_mul_i32 s61, s56, 3
    s_add_u32 s61, s61, s84
L_ib_11:
    s_and_b32 s63, s61, 7
    s_add_u32 s63, s63, 1
    s_lshr_b32 s59, s63, 1
    s_sub_u32 s59, s59, 4
    v_and_b32 v6, 3, v0
    v_add_u32 v6, s59, v6
    s_lshl_b32 s59, s63, 31
    v_xor_b32 v6, s59, v6
    v_and_b32 v6, 0x80000000, v6
    v_min_u32_e64 v7, 55, v0
    v_lshl_or_b32 v6, v7, 7, v6
    s_mul_i32 s59, s63, 7168
    s_lshr_b32 s63, s61, 3
    s_mul_i32 s63, s63, 290816
    s_add_u32 s59, s59, s63
    s_lshr_b32 s63, s53, 1
    s_mul_i32 s63, s63, 1454080
    s_add_u32 s59, s59, s63
    s_and_b32 s63, s53, 1
    s_mul_i32 s63, s63, 71680
    s_add_u32 s59, s59, s63
    buffer_load_dword v10, v6, s[40:43], s59 offen sc1
    s_add_u32 s61, s61, 21
    s_cmp_lt_u32 s61, 40
    s_cbranch_scc1 L_ib_11
    s_mul_i32 s61, s84, 2
    s_add_u32 s59, s61, 2
    s_mul_i32 s63, s84, 6
    s_sub_u32 s63, s63, s56
    s_add_u32 s63, s63, 11
    s_add_u32 s82, s63, 1
    s_cmp_eq_u32 s56, 6
    s_cselect_b32 s61, s61, s63
    s_cselect_b32 s59, s59, s82
    s_cmp_lt_u32 s61, 14
    s_cbranch_scc0 L_aux_nwo
    v_min_u32 v4, 59, v0
    v_mul_u32_u24 v5, 52, v4
    v_lshrrev_b32_e64 v5, 8, v5
    v_mul_u32_u24 v5, 4480, v5
    v_lshl_add_u32 v4, v4, 7, v5
L_aux_wo:
    s_mul_i32 s63, s61, 96
    s_add_u32 s63, s63, s53
    s_mul_i32 s63, s63, 640
    v_add_u32 v5, s63, v4
    buffer_load_dword v10, v5, s[36:39], 0 offen
    s_add_u32 s61, s61, 1
    s_cmp_lt_u32 s61, s59
    s_cbranch_scc1 L_aux_wo
L_aux_nwo:
    s_cmp_ge_u32 s57, 54
    s_cbranch_scc1 L_aux_end
    s_mov_b32 s66, 2211840
    s_mov_b32 s67, 0x20000
    s_mov_b32 s74, 2211840
    s_mov_b32 s75, 0x20000
    s_bitcmp1_b32 s57, 0
    s_cselect_b64 s[64:65], s[16:17], s[14:15]
    s_mov_b64 s[72:73], s[18:19]
    v_and_b32 v4, 6, v1
    v_xor_b32 v4, v4, v2
    v_lshlrev_b32 v4, 4, v4
    v_and_b32 v5, 4, v1
    v_add_u32_e64 v5, v5, v1
    v_mul_u32_u24 v5, 3456, v5
    s_lshr_b32 s63, s57, 1
    s_lshl_b32 s63, s63, 7
    v_add3_u32 v3, s63, v4, v5
    v_mul_u32_u24 v5, 1280, v1
    s_mul_i32 s63, s57, 40960
    v_add3_u32 v4, s63, v4, v5
    s_mov_b32 s61, s84
L_aux_fm:
    s_lshl_b32 m0, s61, 10
    s_and_b32 s63, s61, 1
    s_and_b32 s59, s61, 2
    s_lshl3_add_u32 s63, s63, s59
    s_andn2_b32 s59, s61, 3
    s_lshl2_add_u32 s63, s59, s63
    s_mul_i32 s63, s63, 6912
    buffer_load_dwordx4 v3, s[64:67], s63 offen nt lds
    s_waitcnt vmcnt(10)
    s_add_u32 s61, s61, 3
    s_cmp_lt_u32 s61, 80
    s_cbranch_scc1 L_aux_fm
    s_mov_b32 s61, s84
L_fd_12:
    s_lshl_b32 s63, s61, 10
    s_add_u32 m0, s63, 81920
    s_and_b32 s63, s61, 3
    s_mul_i32 s63, s63, 10240
    s_lshr_b32 s59, s61, 2
    s_lshl_b32 s59, s59, 7
    s_add_u32 s63, s63, s59
    buffer_load_dwordx4 v4, s[72:75], s63 offen nt lds
    s_add_u32 s61, s61, 3
    s_cmp_lt_u32 s61, 6
    s_cbranch_scc1 L_fd_12
    s_waitcnt vmcnt(10)
    s_barrier
L_fd_13:
    s_lshl_b32 s63, s61, 10
    s_add_u32 m0, s63, 81920
    s_and_b32 s63, s61, 3
    s_mul_i32 s63, s63, 10240
    s_lshr_b32 s59, s61, 2
    s_lshl_b32 s59, s59, 7
    s_add_u32 s63, s63, s59
    buffer_load_dwordx4 v4, s[72:75], s63 offen nt lds
    s_add_u32 s61, s61, 3
    s_cmp_lt_u32 s61, 24
    s_cbranch_scc1 L_fd_13
    s_waitcnt vmcnt(8)
    s_barrier
    s_cmp_lt_u32 s61, 40
    s_cbranch_scc0 L_aux_dnd
L_fd_14:
    s_lshl_b32 s63, s61, 10
    s_add_u32 m0, s63, 81920
    s_and_b32 s63, s61, 3
    s_mul_i32 s63, s63, 10240
    s_lshr_b32 s59, s61, 2
    s_lshl_b32 s59, s59, 7
    s_add_u32 s63, s63, s59
    buffer_load_dwordx4 v4, s[72:75], s63 offen nt lds
    s_add_u32 s61, s61, 3
    s_cmp_lt_u32 s61, 40
    s_cbranch_scc1 L_fd_14
L_aux_dnd:
    s_barrier
    s_waitcnt vmcnt(0)
    s_barrier
    s_branch L_aux_d2
    s_nop 0
L_aux_f1:
    v_bfe_u32 v9, v0, 3, 2
    v_xor_b32 v9, s52, v9
    v_lshlrev_b32 v9, 5, v9
    v_and_b32_e64 v10, 3, v0
    v_lshl_add_u32 v9, v10, 3, v9
    v_lshrrev_b32_e64 v10, 2, v0
    v_lshl_add_u32 v9, v10, 7, v9
    v_add_u32_e64 v1, 0, v9
    v_add_u32 v170, 40960, v1
    s_lshl_b32 s63, s52, 12
    s_add_u32 s63, s63, 81920
    v_bfe_u32 v9, v0, 3, 2
    v_lshlrev_b32 v9, 5, v9
    v_and_b32_e64 v10, 3, v0
    v_lshl_add_u32 v9, v10, 3, v9
    v_lshrrev_b32_e64 v10, 2, v0
    v_lshl_add_u32 v9, v10, 7, v9
    v_add_u32 v172, s63, v9
    v_xor_b32 v173, 32, v172
    v_xor_b32_e64 v174, 64, v172
    v_xor_b32 v175, 96, v172
    v_and_b32_e64 v3, 48, v0
    v_add_u32 v176, 129024, v3
    v_lshlrev_b32 v177, 2, v0
    v_mov_b64 v[180:181], 0
    v_mov_b64 v[182:183], 0
    v_mov_b64 v[184:185], 0
    v_mov_b64 v[186:187], 0
    v_mov_b64 v[188:189], 0
    v_mov_b64 v[190:191], 0
    v_mov_b64 v[192:193], 0
    v_mov_b64_e64 v[194:195], 0
    s_and_b32 s58, s57, 1
    s_and_b32 s63, s52, 1
    s_lshl1_add_u32 s59, s58, s63
    s_lshl_b32 s59, s59, 6
    s_add_u32 s59, s59, 129024
    v_add_u32 v178, s59, v177
    s_xor_b32 s59, s57, 1
    s_lshl1_add_u32 s59, s59, s63
    s_lshl_b32 s59, s59, 6
    s_add_u32 s59, s59, 5954560
    s_mul_i32 s61, s57, 2560
    s_lshl_b32 s63, s52, 8
    s_add_u32 s61, s61, s63
    s_add_u32 s61, s61, 5816320
    v_add_u32 v2, 126976, v3
L_aux_xs:
    s_sleep 2
    ds_read_b32 v6, v7 offset:8
    s_waitcnt lgkmcnt(0)
    v_cmp_eq_u32 vcc, 0, v6
    s_cbranch_vccnz L_aux_xs
    ds_read_b128 v[12:15], v2 offset:0
    ds_read_b128 v[20:23], v2 offset:64
    ds_read_b128 v[28:31], v2 offset:128
    ds_read_b128 v[36:39], v2 offset:192
    ds_read_b128 v[44:47], v2 offset:256
    ds_read_b128 v[52:55], v2 offset:320
    ds_read_b128 v[60:63], v2 offset:384
    ds_read_b128 v[68:71], v2 offset:448
    ds_read_b128 v[76:79], v2 offset:512
    ds_read_b128 v[84:87], v2 offset:576
    ds_read_b128 v[92:95], v2 offset:640
    ds_read_b128 v[100:103], v2 offset:704
    ds_read_b128 v[108:111], v2 offset:768
    ds_read_b128 v[116:119], v2 offset:832
    ds_read_b128 v[124:127], v2 offset:896
    ds_read_b128 v[132:135], v2 offset:960
    ds_read_b128 v[140:143], v2 offset:1024
    ds_read_b128 v[148:151], v2 offset:1088
    ds_read_b128 v[156:159], v2 offset:1152
    ds_read_b128 v[164:167], v2 offset:1216
    s_barrier
    s_nop 0
    ds_read_b64_tr_b16 v[8:9], v1 offset:0
    ds_read_b64_tr_b16 v[10:11], v1 offset:2048
    ds_read_b64_tr_b16 v[16:17], v1 offset:4096
    ds_read_b64_tr_b16 v[18:19], v1 offset:6144
    ds_read_b64_tr_b16 v[24:25], v1 offset:8192
    ds_read_b64_tr_b16 v[26:27], v1 offset:10240
    ds_read_b64_tr_b16 v[32:33], v1 offset:12288
    ds_read_b64_tr_b16 v[34:35], v1 offset:14336
    ds_read_b64_tr_b16 v[40:41], v1 offset:16384
    ds_read_b64_tr_b16 v[42:43], v1 offset:18432
    ds_read_b64_tr_b16 v[48:49], v1 offset:20480
    ds_read_b64_tr_b16 v[50:51], v1 offset:22528
    ds_read_b64_tr_b16 v[56:57], v1 offset:24576
    ds_read_b64_tr_b16 v[58:59], v1 offset:26624
    s_waitcnt lgkmcnt(12)
    v_mfma_f32_16x16x32_bf16 v[4:7], v[12:15], v[8:11], 0
    ds_read_b64_tr_b16 v[64:65], v1 offset:28672
    ds_read_b64_tr_b16 v[66:67], v1 offset:30720
    s_waitcnt lgkmcnt(12)
    v_mfma_f32_16x16x32_bf16 v[4:7], v[20:23], v[16:19], v[4:7]
    ds_read_b64_tr_b16 v[72:73], v1 offset:32768
    ds_read_b64_tr_b16 v[74:75], v1 offset:34816
    s_waitcnt lgkmcnt(12)
    v_mfma_f32_16x16x32_bf16 v[4:7], v[28:31], v[24:27], v[4:7]
    ds_read_b64_tr_b16 v[80:81], v1 offset:36864
    ds_read_b64_tr_b16 v[82:83], v1 offset:38912
    s_waitcnt lgkmcnt(12)
    v_mfma_f32_16x16x32_bf16 v[4:7], v[36:39], v[32:35], v[4:7]
    ds_read_b64_tr_b16 v[88:89], v170 offset:0
    ds_read_b64_tr_b16 v[90:91], v170 offset:2048
    s_waitcnt lgkmcnt(12)
    v_mfma_f32_16x16x32_bf16 v[4:7], v[44:47], v[40:43], v[4:7]
    ds_read_b64_tr_b16 v[96:97], v170 offset:4096
    ds_read_b64_tr_b16 v[98:99], v170 offset:6144
    s_waitcnt lgkmcnt(12)
    v_mfma_f32_16x16x32_bf16 v[4:7], v[52:55], v[48:51], v[4:7]
    ds_read_b64_tr_b16 v[104:105], v170 offset:8192
    ds_read_b64_tr_b16 v[106:107], v170 offset:10240
    s_waitcnt lgkmcnt(12)
    v_mfma_f32_16x16x32_bf16 v[4:7], v[60:63], v[56:59], v[4:7]
    ds_read_b64_tr_b16 v[112:113], v170 offset:12288
    ds_read_b64_tr_b16 v[114:115], v170 offset:14336
    s_waitcnt lgkmcnt(12)
    v_mfma_f32_16x16x32_bf16 v[4:7], v[68:71], v[64:67], v[4:7]
    s_waitcnt lgkmcnt(10)
    v_mfma_f32_16x16x32_bf16 v[4:7], v[76:79], v[72:75], v[4:7]
    s_waitcnt lgkmcnt(8)
    v_mfma_f32_16x16x32_bf16 v[4:7], v[84:87], v[80:83], v[4:7]
    s_waitcnt lgkmcnt(6)
    v_mfma_f32_16x16x32_bf16 v[4:7], v[92:95], v[88:91], v[4:7]
    s_waitcnt lgkmcnt(4)
    v_mfma_f32_16x16x32_bf16 v[4:7], v[100:103], v[96:99], v[4:7]
    s_waitcnt lgkmcnt(2)
    v_mfma_f32_16x16x32_bf16 v[4:7], v[108:111], v[104:107], v[4:7]
    s_waitcnt lgkmcnt(0)
    v_mfma_f32_16x16x32_bf16 v[4:7], v[116:119], v[112:115], v[4:7]
    s_barrier
    s_nop 0
    ds_read_b64_tr_b16 v[120:121], v170 offset:16384
    ds_read_b64_tr_b16 v[122:123], v170 offset:18432
    ds_read_b64_tr_b16 v[128:129], v170 offset:20480
    ds_read_b64_tr_b16 v[130:131], v170 offset:22528
    ds_read_b64_tr_b16 v[136:137], v170 offset:24576
    ds_read_b64_tr_b16 v[138:139], v170 offset:26624
    ds_read_b64_tr_b16 v[144:145], v170 offset:28672
    ds_read_b64_tr_b16 v[146:147], v170 offset:30720
    ds_read_b64_tr_b16 v[152:153], v170 offset:32768
    ds_read_b64_tr_b16 v[154:155], v170 offset:34816
    ds_read_b64_tr_b16 v[160:161], v170 offset:36864
    ds_read_b64_tr_b16 v[162:163], v170 offset:38912
    s_waitcnt lgkmcnt(10)
    v_mfma_f32_16x16x32_bf16 v[4:7], v[124:127], v[120:123], v[4:7]
    s_waitcnt lgkmcnt(8)
    v_mfma_f32_16x16x32_bf16 v[4:7], v[132:135], v[128:131], v[4:7]
    s_waitcnt lgkmcnt(6)
    v_mfma_f32_16x16x32_bf16 v[4:7], v[140:143], v[136:139], v[4:7]
    s_waitcnt lgkmcnt(4)
    v_mfma_f32_16x16x32_bf16 v[4:7], v[148:151], v[144:147], v[4:7]
    s_waitcnt lgkmcnt(2)
    v_mfma_f32_16x16x32_bf16 v[4:7], v[156:159], v[152:155], v[4:7]
    s_waitcnt lgkmcnt(0)
    v_mfma_f32_16x16x32_bf16 v[4:7], v[164:167], v[160:163], v[4:7]
    s_mov_b64 exec, 0xffff
    s_lshr_b32 s63, s52, 1
    s_nop 5
    s_cmp_eq_u32 s58, 0
    s_cbranch_scc0 L_aux_noact
    v_mul_f32 v5, 0xbfb8aa3b, v4
    v_exp_f32 v5, v5
    s_nop 0
    v_add_f32 v5, 1.0, v5
    v_rcp_f32 v5, v5
    s_nop 0
    v_mul_f32 v4, v4, v5
L_aux_noact:
    s_cmp_eq_u32 s63, s58
    s_cbranch_scc1 L_aux_keep
    buffer_store_dword v4, v177, s[40:43], s59 offen sc1
    s_branch L_aux_kept
    s_nop 0
L_aux_keep:
    ds_write_b32 v178, v4
L_aux_kept:
    s_mov_b64 exec, -1
    s_waitcnt lgkmcnt(0)
    s_barrier
    ds_read_b128 v[8:11], v176 offset:0
    ds_read_b128 v[12:15], v176 offset:64
    ds_read_b128 v[16:19], v176 offset:128
    ds_read_b128 v[20:23], v176 offset:192
    s_waitcnt lgkmcnt(0)
    v_pk_mul_f32 v[24:25], v[8:9], v[16:17]
    v_pk_mul_f32 v[26:27], v[10:11], v[18:19]
    v_pk_mul_f32 v[28:29], v[12:13], v[20:21]
    v_pk_mul_f32 v[30:31], v[14:15], v[22:23]
    v_cvt_pk_bf16_f32 v32, v24, v25
    v_cvt_pk_bf16_f32 v33, v26, v27
    v_cvt_pk_bf16_f32 v34, v28, v29
    v_cvt_pk_bf16_f32 v35, v30, v31
    s_mov_b32 exec_lo, 65537
    s_mov_b32 exec_hi, exec_lo
    v_mov_b64 v[180:181], v[32:33]
    v_mov_b64_e64 v[182:183], v[34:35]
    s_mov_b32 exec_lo, 1048592
    s_mov_b32 exec_hi, exec_lo
    v_mov_b64 v[184:185], v[32:33]
    v_mov_b64_e64 v[186:187], v[34:35]
    s_mov_b32 exec_lo, 16777472
    s_mov_b32 exec_hi, exec_lo
    v_mov_b64 v[188:189], v[32:33]
    v_mov_b64_e64 v[190:191], v[34:35]
    s_mov_b32 exec_lo, 268439552
    s_mov_b32 exec_hi, exec_lo
    v_mov_b64 v[192:193], v[32:33]
    v_mov_b64 v[194:195], v[34:35]
    s_mov_b64 exec, -1
    s_cmp_lt_u32 s52, 2
    s_barrier
    ds_read_b64_tr_b16 v[80:81], v172 offset:0
    ds_read_b64_tr_b16 v[82:83], v172 offset:2048
    ds_read_b64_tr_b16 v[84:85], v173 offset:0
    ds_read_b64_tr_b16 v[86:87], v173 offset:2048
    ds_read_b64_tr_b16 v[88:89], v174 offset:0
    ds_read_b64_tr_b16 v[90:91], v174 offset:2048
    ds_read_b64_tr_b16 v[92:93], v175 offset:0
    ds_read_b64_tr_b16 v[94:95], v175 offset:2048
    ds_read_b64_tr_b16 v[96:97], v172 offset:16384
    ds_read_b64_tr_b16 v[98:99], v172 offset:18432
    ds_read_b64_tr_b16 v[100:101], v173 offset:16384
    ds_read_b64_tr_b16 v[102:103], v173 offset:18432
    ds_read_b64_tr_b16 v[104:105], v174 offset:16384
    ds_read_b64_tr_b16 v[106:107], v174 offset:18432
    ds_read_b64_tr_b16 v[108:109], v175 offset:16384
    ds_read_b64_tr_b16 v[110:111], v175 offset:18432
    ds_read_b64_tr_b16 v[112:113], v172 offset:32768
    ds_read_b64_tr_b16 v[114:115], v172 offset:34816
    ds_read_b64_tr_b16 v[116:117], v173 offset:32768
    ds_read_b64_tr_b16 v[118:119], v173 offset:34816
    ds_read_b64_tr_b16 v[120:121], v174 offset:32768
    ds_read_b64_tr_b16 v[122:123], v174 offset:34816
    ds_read_b64_tr_b16 v[124:125], v175 offset:32768
    ds_read_b64_tr_b16 v[126:127], v175 offset:34816
    s_waitcnt lgkmcnt(15)
    v_mfma_f32_16x16x32_bf16 v[128:131], v[180:183], v[80:83], 0
    v_mfma_f32_16x16x32_bf16 v[128:131], v[184:187], v[84:87], v[128:131]
    v_mfma_f32_16x16x32_bf16 v[128:131], v[188:191], v[88:91], v[128:131]
    v_mfma_f32_16x16x32_bf16 v[128:131], v[192:195], v[92:95], v[128:131]
    s_waitcnt lgkmcnt(8)
    v_mfma_f32_16x16x32_bf16 v[132:135], v[180:183], v[96:99], 0
    v_mfma_f32_16x16x32_bf16 v[132:135], v[184:187], v[100:103], v[132:135]
    v_mfma_f32_16x16x32_bf16 v[132:135], v[188:191], v[104:107], v[132:135]
    v_mfma_f32_16x16x32_bf16 v[132:135], v[192:195], v[108:111], v[132:135]
    s_waitcnt lgkmcnt(0)
    v_mfma_f32_16x16x32_bf16 v[136:139], v[180:183], v[112:115], 0
    v_mfma_f32_16x16x32_bf16 v[136:139], v[184:187], v[116:119], v[136:139]
    v_mfma_f32_16x16x32_bf16 v[136:139], v[188:191], v[120:123], v[136:139]
    v_mfma_f32_16x16x32_bf16 v[136:139], v[192:195], v[124:127], v[136:139]
    buffer_store_dword v128, v177, s[40:43], s61 offen offset:0 sc1
    s_nop 1
    buffer_store_dword v132, v177, s[40:43], s61 offen offset:1024 sc1
    s_cbranch_scc0 L_aux_d2
    s_nop 2
    buffer_store_dword v136, v177, s[40:43], s61 offen offset:2048 sc1
L_aux_d2:
    s_sub_u32 s57, s57, 32
    s_cmp_lt_u32 s57, 10
    s_cbranch_scc0 L_aux_end
    v_and_b32 v4, 15, v0
    v_lshrrev_b32 v1, 4, v0
    s_lshl_b32 s63, s52, 3
    v_add_u32_e64 v1, s63, v1
    v_mul_u32_u24 v2, 2560, v1
    v_lshl_add_u32 v2, v4, 4, v2
    s_lshl_b32 s63, s57, 8
    s_add_u32 s63, s63, 5816320
    v_add_u32 v2, s63, v2
    v_add_u32 v3, 10240, v2
    s_mov_b64 s[64:65], s[40:41]
    s_mov_b32 s66, 5954560
    s_mov_b32 s67, 0x20000
    s_lshl_b32 s63, s52, 10
    v_lshl_add_u32 v7, v0, 4, s63
    s_mov_b32 s61, 0
L_yr:
    s_sleep 2
    buffer_load_dwordx4 v[72:75], v2, s[64:67], 0 offen sc1
    buffer_load_dwordx4 v[76:79], v3, s[64:67], 0 offen sc1
    s_add_u32 s61, s61, 1
    s_cmp_lt_u32 s61, 30000
    s_waitcnt vmcnt(0)
    v_max3_u32 v6, v72, v73, v74
    v_max3_u32 v6, v6, v75, v76
    v_max3_u32 v6, v6, v77, v78
    v_max_u32 v6, v6, v79
    v_cmp_eq_u32 vcc, -1, v6
    s_cbranch_scc0 L_yrok
    s_cbranch_vccnz L_yr
L_yrok:
    v_pk_add_f32 v[72:73], v[72:73], v[76:77]
    v_pk_add_f32 v[74:75], v[74:75], v[78:79]
    ds_write_b128 v7, v[72:75]
    s_and_b32 s63, s84, 0xffff0000
    s_cmp_lt_i32 s84, 0
    s_cselect_b32 s61, 0, 0x7fff0000
    s_xor_b32 s63, s63, s61
    s_xor_b32 s63, s63, 0x80000000
    v_mov_b32_e64 v5, s63
    v_mul_f32 v5, 0xbfb8aa3b, v5
    v_exp_f32 v5, v5
    s_nop 0
    v_add_f32 v5, 1.0, v5
    v_rcp_f32_e64 v5, v5
    s_nop 0
    v_cvt_pk_bf16_f32 v5, v5, v5
    v_and_b32 v5, 0xffff0000, v5
    v_lshlrev_b32 v1, 4, v0
    s_lshl_b32 s63, s57, 8
    s_add_u32 s63, s63, 5971968
    s_cmp_eq_u32 s52, 4
    s_waitcnt lgkmcnt(0)
    s_barrier
    s_cbranch_scc0 L_aux_end
    ds_read_b128 v[72:75], v1 offset:0
    ds_read_b128 v[76:79], v1 offset:1024
    ds_read_b128 v[80:83], v1 offset:2048
    ds_read_b128 v[84:87], v1 offset:3072
    ds_read_b128 v[88:91], v1 offset:4096
    ds_read_b128 v[92:95], v1 offset:5120
    ds_read_b128 v[96:99], v1 offset:6144
    s_waitcnt lgkmcnt(5)
    v_pk_add_f32 v[72:73], v[72:73], v[76:77]
    v_pk_add_f32 v[74:75], v[74:75], v[78:79]
    s_waitcnt lgkmcnt(4)
    v_pk_add_f32 v[72:73], v[72:73], v[80:81]
    v_pk_add_f32 v[74:75], v[74:75], v[82:83]
    s_waitcnt lgkmcnt(3)
    v_pk_add_f32 v[72:73], v[72:73], v[84:85]
    v_pk_add_f32 v[74:75], v[74:75], v[86:87]
    s_waitcnt lgkmcnt(2)
    v_pk_add_f32 v[72:73], v[72:73], v[88:89]
    v_pk_add_f32 v[74:75], v[74:75], v[90:91]
    s_waitcnt lgkmcnt(1)
    v_pk_add_f32 v[72:73], v[72:73], v[92:93]
    v_pk_add_f32 v[74:75], v[74:75], v[94:95]
    s_waitcnt lgkmcnt(0)
    v_pk_add_f32 v[72:73], v[72:73], v[96:97]
    v_pk_add_f32 v[74:75], v[74:75], v[98:99]
    v_mov_b32 v76, v72
    v_mov_b32 v77, v73
    v_mov_b32 v78, v74
    v_mov_b32 v79, v75
    v_permlane16_swap_b32 v72, v76
    v_permlane16_swap_b32 v73, v77
    v_permlane16_swap_b32 v74, v78
    v_permlane16_swap_b32 v75, v79
    v_add_f32 v72, v72, v76
    v_add_f32 v73, v73, v77
    v_add_f32 v74, v74, v78
    v_add_f32 v75, v75, v79
    v_mov_b32 v76, v72
    v_mov_b32 v77, v73
    v_mov_b32 v78, v74
    v_mov_b32 v79, v75
    v_permlane32_swap_b32 v72, v76
    v_permlane32_swap_b32 v73, v77
    v_permlane32_swap_b32 v74, v78
    v_permlane32_swap_b32 v75, v79
    v_add_f32 v72, v72, v76
    v_add_f32 v73, v73, v77
    v_add_f32 v74, v74, v78
    v_add_f32 v75, v75, v79
    v_cvt_pk_bf16_f32 v72, v72, v72
    v_and_b32 v72, 0xffff0000, v72
    v_mul_f32_e64 v72, v72, v5
    v_cvt_pk_bf16_f32 v72, v72, v72
    v_and_b32 v72, 0xffff0000, v72
    v_cvt_pk_bf16_f32 v73, v73, v73
    v_and_b32 v73, 0xffff0000, v73
    v_mul_f32_e64 v73, v73, v5
    v_cvt_pk_bf16_f32 v73, v73, v73
    v_and_b32 v73, 0xffff0000, v73
    v_cvt_pk_bf16_f32 v74, v74, v74
    v_and_b32 v74, 0xffff0000, v74
    v_mul_f32_e64 v74, v74, v5
    v_cvt_pk_bf16_f32 v74, v74, v74
    v_and_b32 v74, 0xffff0000, v74
    v_cvt_pk_bf16_f32 v75, v75, v75
    v_and_b32 v75, 0xffff0000, v75
    v_mul_f32_e64 v75, v75, v5
    v_cvt_pk_bf16_f32 v75, v75, v75
    v_and_b32 v75, 0xffff0000, v75
    s_mov_b64 exec, 0xffff
    buffer_store_dwordx4 v[72:75], v1, s[40:43], s63 offen sc1
    s_mov_b64 exec, -1
L_aux_end:
L_end:
    s_endpgm
.section .rodata,"a"
.p2align 6
.amdhsa_kernel gated_mix__sliding_local_dilated__moe_arch_mod__prompt_kernel
  .amdhsa_next_free_vgpr 256
  .amdhsa_next_free_sgpr 102
  .amdhsa_accum_offset 256
  .amdhsa_group_segment_fixed_size 0
  .amdhsa_kernarg_size 96
  .amdhsa_user_sgpr_count 2
  .amdhsa_user_sgpr_kernarg_segment_ptr 1
  .amdhsa_system_sgpr_workgroup_id_x 1
  .amdhsa_float_denorm_mode_32 3
.end_amdhsa_kernel
```
